```python
import torch

def _softmax(x, axis=-1):
    return torch.softmax(x, dim=axis)

def _gelu(x):
    return torch.nn.functional.gelu(x, approximate='tanh')

def _silu(x):
    return torch.nn.functional.silu(x)

def _sigmoid(x):
    return torch.sigmoid(x)

def _layernorm(x, axis=-1, eps=1e-05):
    m = x.mean(dim=axis, keepdim=True)
    v = x.var(dim=axis, keepdim=True, unbiased=False)
    return (x - m) / torch.sqrt(v + eps)

def _scatter_add(tgt, idx, src, axis=0):
    return tgt.clone().index_add_(axis, idx, src)

def _segment_sum(src, seg, n):
    out = torch.zeros((n,) + src.shape[1:], dtype=src.dtype)
    return out.index_add_(0, seg, src)

def _pad(x, pw):
    flat = tuple((v for pair in reversed(pw) for v in pair))
    return torch.nn.functional.pad(x, flat)
kernel_name = 'gated_mix__memory_aug_recurrent_mem_tr__moe_arch_mod__prompt'

def setup_inputs():

    _w = lambda a: (lambda t: t.to(torch.bfloat16) if t.is_floating_point() else t)(torch.as_tensor(a))

    def _A_setup():
        B, S, Dm = (1, 2048, 448)
        H, Dh = (16, 256)
        M, seg = (8, 32)
        seg = min(seg, S)
        S = S // seg * seg
        return {'x': _w((lambda *s: torch.randn(*s, dtype=torch.bfloat16) * 0.05)(B, S, Dm)), 'mem0': _w((lambda *s: torch.randn(*s, dtype=torch.bfloat16) * 0.8)(B, M, Dm)), 'Wq': _w((lambda *s: torch.randn(*s, dtype=torch.bfloat16) * 1.6)(Dm, H, Dh) * Dm ** (-0.5)), 'Wk': _w((lambda *s: torch.randn(*s, dtype=torch.bfloat16) * 1.6)(Dm, H, Dh) * Dm ** (-0.5)), 'Wv': _w((lambda *s: torch.randn(*s, dtype=torch.bfloat16) * 0.8)(Dm, H, Dh) * Dm ** (-0.5)), 'Wo': _w((lambda *s: torch.randn(*s, dtype=torch.bfloat16) * 0.8)(H, Dh, Dm) * (H * Dh) ** (-0.5)), 'seg_len': seg}
    _A_in = _A_setup()

    def _B_setup():
        B, S, D, F, C = (1, 2048, 448, 1792, 1)
        return {'x': _w((lambda *s: torch.randn(*s, dtype=torch.bfloat16) * 0.05)(B, S, D)), 'w_r': _w((lambda *s: torch.randn(*s, dtype=torch.bfloat16) * 1.6)(D)), 'w_gate': _w((lambda *s: torch.randn(*s, dtype=torch.bfloat16) * 0.2)(D, F)), 'w_up': _w((lambda *s: torch.randn(*s, dtype=torch.bfloat16) * 0.2)(D, F)), 'w_down': _w((lambda *s: torch.randn(*s, dtype=torch.bfloat16) * 0.2)(F, D))}
    _B_in = _B_setup()
    return {'A_x': _A_in['x'], 'A_mem0': _A_in['mem0'], 'A_Wq': _A_in['Wq'], 'A_Wk': _A_in['Wk'], 'A_Wv': _A_in['Wv'], 'A_Wo': _A_in['Wo'], 'A_seg_len': _A_in['seg_len'], 'B_x': _B_in['x'], 'B_w_r': _B_in['w_r'], 'B_w_gate': _B_in['w_gate'], 'B_w_up': _B_in['w_up'], 'B_w_down': _B_in['w_down'], 'gate_w': _w((lambda *s: torch.randn(*s, dtype=torch.bfloat16) * 0.05)(448) * 16.0)}

def reference(A_x, A_mem0, A_Wq, A_Wk, A_Wv, A_Wo, A_seg_len, B_x, B_w_r, B_w_gate, B_w_up, B_w_down, gate_w):

    def _A_ref(x, mem0, Wq, Wk, Wv, Wo, seg_len):
        B, S, Dm = x.shape
        H, Dh = (Wq.shape[1], Wq.shape[2])
        M = mem0.shape[1]
        scale = Dh ** (-0.5)
        n_seg = S // seg_len
        L = M + seg_len
        idx = torch.arange(L)
        mask = (idx[:, None] < M) | (idx[:, None] >= idx[None, :])
        mem = mem0
        outs = []
        for s in range(n_seg):
            xs = x[:, s * seg_len:(s + 1) * seg_len, :].clone()
            h = torch.concatenate([mem, xs], axis=1)
            q = torch.einsum('btd,dhe->bhte', h, Wq)
            k = torch.einsum('btd,dhe->bhte', h, Wk)
            v = torch.einsum('btd,dhe->bhte', h, Wv)
            scores = torch.einsum('bhqe,bhke->bhqk', q, k) * scale
            scores = torch.where(mask[None, None], scores, -1000000000.0)
            p = _softmax(scores, axis=-1)
            o = torch.einsum('bhqk,bhke->bhqe', p, v)
            o = torch.einsum('bhte,hed->btd', o, Wo)
            mem = o[:, :M, :].clone()
            outs.append(o[:, M:, :])
        return torch.concatenate(outs, axis=1)

    def _B_ref(x, w_r, w_gate, w_up, w_down):
        B, S, D = x.shape
        C = 1
        r = x @ w_r
        idx = torch.argsort(-r, axis=-1)[:, :C]
        idx_e = (lambda x, n, axis: torch.repeat_interleave(x, n, dim=axis))(idx.reshape(B, C, 1), D, axis=2)
        x_sel = (lambda x, i, axis: torch.take_along_dim(x, i, dim=axis))(x, idx_e, axis=1)
        g = _silu(x_sel @ w_gate)
        u = x_sel @ w_up
        y = g * u @ w_down
        r_sel = _sigmoid((lambda x, i, axis: torch.take_along_dim(x, i, dim=axis))(r, idx, axis=1))
        y = y * r_sel.reshape(B, C, 1)
        b_off = (torch.arange(B) * S).reshape(B, 1)
        flat_idx = (idx + b_off).reshape(B * C)
        zero = (x * 0.0).reshape(B * S, D)
        upd = _scatter_add(zero, flat_idx, y.reshape(B * C, D), axis=0)
        return x + upd.reshape(B, S, D)
    x = A_x
    g = _sigmoid((x * gate_w).sum(-1, keepdims=True))
    a = _A_ref(x, A_mem0, A_Wq, A_Wk, A_Wv, A_Wo, A_seg_len)
    b = _B_ref(x, B_w_r, B_w_gate, B_w_up, B_w_down)
    return g * a + (1 - g) * b
```

```asm
; @launch grid=(256,1,1) block=(256,1,1) lds=163840
.amdgcn_target "amdgcn-amd-amdhsa--gfx950"
.text
.globl gated_mix__memory_aug_recurrent_mem_tr__moe_arch_mod__prompt_kernel
.p2align 8
.type gated_mix__memory_aug_recurrent_mem_tr__moe_arch_mod__prompt_kernel,@function
gated_mix__memory_aug_recurrent_mem_tr__moe_arch_mod__prompt_kernel:
    s_cmp_ge_u32 s2, 256
    s_cbranch_scc1 L_exit
    s_load_dwordx2 s[4:5], s[0:1], 0
    s_load_dwordx4 s[8:11], s[0:1], 104
    s_load_dwordx2 s[12:13], s[0:1], 120
    s_load_dwordx16 s[60:75], s[0:1], 8
    s_load_dwordx2 s[76:77], s[0:1], 96
    v_lshrrev_b32 v1, 6, v0
    s_getreg_b32 s44, hwreg(HW_REG_XCC_ID)
    v_readfirstlane_b32 s28, v1
    s_and_b32 s44, s44, 15
    s_min_u32 s44, s44, 8
    s_lshl_b32 s41, s44, 5
    s_cmp_eq_u32 s44, 8
    s_cselect_b32 s41, 28, s41
    v_mov_b32 v2, s41
    v_accvgpr_write_b32 a255, 1
    s_mov_b32 s18, 0x10000000
    s_mov_b32 s19, 0x20000
    s_mov_b32 s22, 1835008
    s_mov_b32 s23, 0x20000
    s_mov_b32 s26, 256
    s_mov_b32 s27, 0x20000
    s_and_b32 s41, s2, 7
    s_lshr_b32 s42, s2, 3
    s_waitcnt lgkmcnt(0)
    s_mov_b32 s16, s12
    s_mov_b32 s17, s13
    s_mov_b32 s20, s4
    s_mov_b32 s21, s5
    s_mov_b32 s24, s10
    s_mov_b32 s25, s11
    v_mov_b32 v3, 95141888
    buffer_load_dword a254, v3, s[16:19], 0 offen sc1
    s_cmp_lg_u32 s28, 0
    s_cbranch_scc1 L_noatom
    s_mov_b64 exec, 1
    buffer_atomic_add a255, v2, s[24:27], 0 offen sc0 sc1
    s_mov_b64 exec, -1
L_noatom:
    s_cmp_eq_u32 s41, 0
    s_cbranch_scc1 L_unit_misc
    s_sub_u32 s41, s41, 1
    s_lshl_b32 s41, s41, 5
    s_add_u32 s42, s42, s41
    v_and_b32 v1, 63, v0
    s_mul_i32 s56, s42, 4682
    s_lshr_b32 s56, s56, 16
    s_mul_i32 s82, s56, 14
    s_sub_u32 s82, s42, s82
    s_lshr_b32 s57, s82, 1
    s_and_b32 s58, s82, 1
    s_mul_i32 s58, s58, 7
    v_lshrrev_b32 v6, 5, v1
    v_and_b32 v7, 31, v1
    v_xor_b32 v7, v7, v6
    v_lshlrev_b32 v7, 4, v7
    v_lshl_add_u32 v24, v6, 13, v7
    v_xor_b32 v25, 32, v24
    v_xor_b32 v26, 64, v24
    v_xor_b32 v27, 64, v25
    s_lshl_b32 s83, s28, 14
    s_lshl_b32 s85, s56, 9
    s_mov_b32 s48, s62
    s_mov_b32 s49, s63
    s_mov_b32 s50, 3670016
    s_mov_b32 s51, 0x20000
    s_mov_b32 s52, s64
    s_mov_b32 s53, s65
    s_mov_b32 s54, s50
    s_mov_b32 s55, 0x20000
    s_movk_i32 s45, 0x4000
    s_lshl2_add_u32 s79, s57, s28
    s_lshl_b32 s79, s79, 17
    s_add_u32 s79, s79, s85
    s_lshl_b32 s80, s28, 13
    s_add_u32 m0, s80, 131072
    s_and_b32 s80, s28, 1
    s_lshl_b32 s80, s80, 7
    v_xor_b32 v12, s80, v24
    v_xor_b32 v13, s80, v25
    v_xor_b32 v14, s80, v26
    v_xor_b32 v15, s80, v27
    s_movk_i32 s80, 0x400
    buffer_load_dwordx4 v12, s[52:55], s79 offen lds
    s_add_u32 s79, s79, s45
    s_add_u32 m0, m0, s80
    s_nop 0
    buffer_load_dwordx4 v13, s[52:55], s79 offen lds
    s_add_u32 s79, s79, s45
    s_add_u32 m0, m0, s80
    s_nop 0
    buffer_load_dwordx4 v12, s[52:55], s79 offen lds
    s_add_u32 s79, s79, s45
    s_add_u32 m0, m0, s80
    s_nop 0
    buffer_load_dwordx4 v13, s[52:55], s79 offen lds
    s_add_u32 s79, s79, s45
    s_add_u32 m0, m0, s80
    s_nop 0
    buffer_load_dwordx4 v14, s[52:55], s79 offen lds
    s_add_u32 s79, s79, s45
    s_add_u32 m0, m0, s80
    s_nop 0
    buffer_load_dwordx4 v15, s[52:55], s79 offen lds
    s_add_u32 s79, s79, s45
    s_add_u32 m0, m0, s80
    s_nop 0
    buffer_load_dwordx4 v14, s[52:55], s79 offen lds
    s_add_u32 s79, s79, s45
    s_add_u32 m0, m0, s80
    s_nop 0
    buffer_load_dwordx4 v15, s[52:55], s79 offen lds
    s_add_u32 s79, s79, s45
    s_add_u32 m0, m0, s80
    s_add_u32 s87, s57, s28
    v_xor_b32 v28, 0x80, v24
    v_xor_b32 v29, 32, v28
    v_xor_b32 v30, 64, v28
    v_xor_b32 v31, 64, v29
    s_sub_u32 s79, s87, 7
    s_min_u32 s79, s79, s87
    s_sub_u32 s81, s79, 7
    s_min_u32 s79, s79, s81
    s_add_u32 s46, s79, s58
    s_lshl_b32 s79, s46, 18
    s_add_u32 s79, s79, s85
    s_mov_b32 m0, s83
    s_xor_b32 s83, s83, 65536
    s_add_u32 s87, s87, 4
    buffer_load_dwordx4 v24, s[48:51], s79 offen lds
    s_add_u32 s79, s79, s45
    s_add_u32 m0, m0, s80
    s_nop 0
    buffer_load_dwordx4 v25, s[48:51], s79 offen lds
    s_add_u32 s79, s79, s45
    s_add_u32 m0, m0, s80
    s_nop 0
    buffer_load_dwordx4 v24, s[48:51], s79 offen lds
    s_add_u32 s79, s79, s45
    s_add_u32 m0, m0, s80
    s_nop 0
    buffer_load_dwordx4 v25, s[48:51], s79 offen lds
    s_add_u32 s79, s79, s45
    s_add_u32 m0, m0, s80
    s_nop 0
    buffer_load_dwordx4 v26, s[48:51], s79 offen lds
    s_add_u32 s79, s79, s45
    s_add_u32 m0, m0, s80
    s_nop 0
    buffer_load_dwordx4 v27, s[48:51], s79 offen lds
    s_add_u32 s79, s79, s45
    s_add_u32 m0, m0, s80
    s_nop 0
    buffer_load_dwordx4 v26, s[48:51], s79 offen lds
    s_add_u32 s79, s79, s45
    s_add_u32 m0, m0, s80
    s_nop 0
    buffer_load_dwordx4 v27, s[48:51], s79 offen lds
    s_add_u32 s79, s79, s45
    s_add_u32 m0, m0, s80
    s_nop 0
    buffer_load_dwordx4 v28, s[48:51], s79 offen lds
    s_add_u32 s79, s79, s45
    s_add_u32 m0, m0, s80
    s_nop 0
    buffer_load_dwordx4 v29, s[48:51], s79 offen lds
    s_add_u32 s79, s79, s45
    s_add_u32 m0, m0, s80
    s_nop 0
    buffer_load_dwordx4 v28, s[48:51], s79 offen lds
    s_add_u32 s79, s79, s45
    s_add_u32 m0, m0, s80
    s_nop 0
    buffer_load_dwordx4 v29, s[48:51], s79 offen lds
    s_add_u32 s79, s79, s45
    s_add_u32 m0, m0, s80
    s_nop 0
    buffer_load_dwordx4 v30, s[48:51], s79 offen lds
    s_add_u32 s79, s79, s45
    s_add_u32 m0, m0, s80
    s_nop 0
    buffer_load_dwordx4 v31, s[48:51], s79 offen lds
    s_add_u32 s79, s79, s45
    s_add_u32 m0, m0, s80
    s_nop 0
    buffer_load_dwordx4 v30, s[48:51], s79 offen lds
    s_add_u32 s79, s79, s45
    s_add_u32 m0, m0, s80
    s_nop 0
    buffer_load_dwordx4 v31, s[48:51], s79 offen lds
    s_add_u32 s79, s79, s45
    s_add_u32 m0, m0, s80
    s_mov_b32 s52, s68
    s_mov_b32 s53, s69
    v_lshrrev_b32 v12, 3, v1
    v_and_b32 v13, 7, v1
    v_mul_u32_u24 v14, 896, v12
    v_lshl_add_u32 v14, v13, 4, v14
    s_lshl2_add_u32 s79, s56, s28
    s_mul_i32 s79, s79, 57344
    s_lshl_b32 s81, s57, 7
    s_add_u32 s79, s79, s81
    s_movk_i32 s81, 7168
    buffer_load_dwordx4 a[0:3], v14, s[52:55], s79 offen
    s_add_u32 s79, s79, s81
    buffer_load_dwordx4 a[4:7], v14, s[52:55], s79 offen
    s_add_u32 s79, s79, s81
    buffer_load_dwordx4 a[8:11], v14, s[52:55], s79 offen
    s_add_u32 s79, s79, s81
    buffer_load_dwordx4 a[12:15], v14, s[52:55], s79 offen
    s_add_u32 s79, s79, s81
    buffer_load_dwordx4 a[16:19], v14, s[52:55], s79 offen
    s_add_u32 s79, s79, s81
    buffer_load_dwordx4 a[20:23], v14, s[52:55], s79 offen
    s_add_u32 s79, s79, s81
    buffer_load_dwordx4 a[24:27], v14, s[52:55], s79 offen
    s_add_u32 s79, s79, s81
    buffer_load_dwordx4 a[28:31], v14, s[52:55], s79 offen
    v_lshrrev_b32 v2, 4, v1
    v_and_b32 v3, 15, v1
    v_lshlrev_b32 v6, 4, v1
    v_lshrrev_b32 v16, 2, v3
    v_lshlrev_b32 v16, 3, v16
    v_and_b32 v17, 3, v3
    v_add_u32 v16, v16, v17
    v_lshlrev_b32 v16, 9, v16
    v_xor_b32 v17, v2, v3
    v_lshl_add_u32 v7, v17, 4, v16
    v_add_u32 v8, 131072, v7
    v_xor_b32 v9, 64, v8
    v_xor_b32 v10, 0x80, v8
    v_xor_b32 v11, 0xc0, v8
    s_lshl_b32 s89, s42, 6
    s_mul_i32 s84, s56, 28
    s_lshl2_add_u32 s84, s57, s84
    s_mul_i32 s84, s84, 14336
    s_cmp_eq_u32 s28, 3
    s_cselect_b32 s88, 1, 2
    s_mov_b32 s86, 0x3db8aa3b
    s_mov_b32 s78, 0
    s_mov_b32 s47, 0
    s_waitcnt vmcnt(24)
    s_barrier
    ds_read_b128 v[128:131], v8 offset:0
    ds_read_b128 v[132:135], v9 offset:0
    ds_read_b128 v[136:139], v10 offset:0
    ds_read_b128 v[140:143], v11 offset:0
    ds_read_b128 v[144:147], v8 offset:256
    ds_read_b128 v[148:151], v9 offset:256
    ds_read_b128 v[152:155], v10 offset:256
    ds_read_b128 v[156:159], v11 offset:256
    ds_read_b128 v[160:163], v8 offset:2048
    ds_read_b128 v[164:167], v9 offset:2048
    ds_read_b128 v[168:171], v10 offset:2048
    ds_read_b128 v[172:175], v11 offset:2048
    ds_read_b128 v[176:179], v8 offset:2304
    ds_read_b128 v[180:183], v9 offset:2304
    ds_read_b128 v[184:187], v10 offset:2304
    ds_read_b128 v[188:191], v11 offset:2304
    ds_read_b128 v[192:195], v8 offset:16384
    ds_read_b128 v[196:199], v9 offset:16384
    ds_read_b128 v[200:203], v10 offset:16384
    ds_read_b128 v[204:207], v11 offset:16384
    ds_read_b128 v[208:211], v8 offset:16640
    ds_read_b128 v[212:215], v9 offset:16640
    ds_read_b128 v[216:219], v10 offset:16640
    ds_read_b128 v[220:223], v11 offset:16640
    ds_read_b128 v[224:227], v8 offset:18432
    ds_read_b128 v[228:231], v9 offset:18432
    ds_read_b128 v[232:235], v10 offset:18432
    ds_read_b128 v[236:239], v11 offset:18432
    ds_read_b128 v[240:243], v8 offset:18688
    ds_read_b128 v[244:247], v9 offset:18688
    ds_read_b128 v[248:251], v10 offset:18688
    ds_read_b128 v[252:255], v11 offset:18688
    s_lshl_b32 s79, s28, 14
    v_add_u32 v8, s79, v7
    v_xor_b32 v9, 64, v8
    v_xor_b32 v10, 0x80, v8
    v_xor_b32 v11, 0xc0, v8
    v_lshlrev_b32 v15, 7, v12
    v_and_b32 v16, 3, v13
    v_lshl_add_u32 v15, v16, 3, v15
    s_lshl_b32 s81, s28, 13
    s_add_u32 s81, s81, 131072
    v_add_u32 v15, s81, v15
    v_lshrrev_b32 v16, 2, v13
    v_lshlrev_b32 v16, 1, v16
    v_bfe_u32 v17, v12, 1, 1
    v_xor_b32 v16, v16, v17
    v_lshl_add_u32 v20, v16, 5, v15
    v_lshrrev_b32 v12, 2, v3
    v_lshl_add_u32 v13, v2, 3, v12
    v_lshlrev_b32 v13, 7, v13
    v_and_b32 v14, 3, v3
    v_lshl_add_u32 v13, v14, 3, v13
    v_add_u32 v13, 131072, v13
    v_lshrrev_b32 v12, 1, v12
    v_and_b32 v14, 1, v2
    v_lshl_add_u32 v12, v14, 1, v12
    v_lshl_add_u32 v21, v12, 5, v13
    v_accvgpr_read_b32 v5, a254
    s_waitcnt lgkmcnt(0)
    s_barrier
    v_add_u32 v5, 1, v5
P_blk:
    s_lshl_b32 s82, s46, 10
    s_add_u32 s82, s82, s84
    s_add_u32 s79, s88, s78
    s_cmp_lg_u32 s79, 1
    s_cselect_b32 s79, 1, s78
    s_cmp_lg_u32 s79, 0
    s_cbranch_scc1 P_nosw
    s_mov_b32 s48, s66
    s_mov_b32 s49, s67
    s_sub_u32 s87, s57, s28
    s_add_u32 s87, s87, 3
P_nosw:
    s_sub_u32 s79, s87, 7
    s_min_u32 s79, s79, s87
    s_sub_u32 s81, s79, 7
    s_min_u32 s79, s79, s81
    s_add_u32 s46, s79, s58
    s_lshl_b32 s79, s46, 18
    s_add_u32 s79, s79, s85
    s_mov_b32 m0, s83
    s_xor_b32 s83, s83, 65536
    s_add_u32 s87, s87, 4
    s_waitcnt vmcnt(4)
    ds_read_b128 v[32:35], v8 offset:0
    ds_read_b128 v[36:39], v8 offset:2048
    ds_read_b128 v[40:43], v9 offset:0
    ds_read_b128 v[44:47], v9 offset:2048
    ds_read_b128 v[48:51], v10 offset:0
    ds_read_b128 v[52:55], v10 offset:2048
    ds_read_b128 v[56:59], v11 offset:0
    ds_read_b128 v[60:63], v11 offset:2048
    ds_read_b128 v[64:67], v8 offset:256
    ds_read_b128 v[68:71], v8 offset:2304
    ds_read_b128 v[72:75], v9 offset:256
    ds_read_b128 v[76:79], v9 offset:2304
    ds_read_b128 v[80:83], v10 offset:256
    ds_read_b128 v[84:87], v10 offset:2304
    ds_read_b128 v[88:91], v11 offset:256
    ds_read_b128 v[92:95], v11 offset:2304
    s_waitcnt lgkmcnt(14)
    v_mfma_f32_16x16x32_bf16 v[96:99], v[32:35], v[128:131], 0
    buffer_load_dwordx4 v24, s[48:51], s79 offen lds
    v_mfma_f32_16x16x32_bf16 v[104:107], v[32:35], v[160:163], 0
    s_add_u32 s79, s79, s45
    s_add_u32 m0, m0, s80
    v_mfma_f32_16x16x32_bf16 v[112:115], v[32:35], v[192:195], 0
    buffer_load_dwordx4 v25, s[48:51], s79 offen lds
    v_mfma_f32_16x16x32_bf16 v[120:123], v[32:35], v[224:227], 0
    s_add_u32 s79, s79, s45
    s_add_u32 m0, m0, s80
    v_mfma_f32_16x16x32_bf16 v[100:103], v[36:39], v[128:131], 0
    buffer_load_dwordx4 v24, s[48:51], s79 offen lds
    v_mfma_f32_16x16x32_bf16 v[108:111], v[36:39], v[160:163], 0
    s_add_u32 s79, s79, s45
    s_add_u32 m0, m0, s80
    v_mfma_f32_16x16x32_bf16 v[116:119], v[36:39], v[192:195], 0
    buffer_load_dwordx4 v25, s[48:51], s79 offen lds
    v_mfma_f32_16x16x32_bf16 v[124:127], v[36:39], v[224:227], 0
    s_add_u32 s79, s79, s45
    s_add_u32 m0, m0, s80
    s_waitcnt lgkmcnt(12)
    v_mfma_f32_16x16x32_bf16 v[96:99], v[40:43], v[132:135], v[96:99]
    buffer_load_dwordx4 v26, s[48:51], s79 offen lds
    v_mfma_f32_16x16x32_bf16 v[104:107], v[40:43], v[164:167], v[104:107]
    s_add_u32 s79, s79, s45
    s_add_u32 m0, m0, s80
    v_mfma_f32_16x16x32_bf16 v[112:115], v[40:43], v[196:199], v[112:115]
    buffer_load_dwordx4 v27, s[48:51], s79 offen lds
    v_mfma_f32_16x16x32_bf16 v[120:123], v[40:43], v[228:231], v[120:123]
    s_add_u32 s79, s79, s45
    s_add_u32 m0, m0, s80
    v_mfma_f32_16x16x32_bf16 v[100:103], v[44:47], v[132:135], v[100:103]
    buffer_load_dwordx4 v26, s[48:51], s79 offen lds
    v_mfma_f32_16x16x32_bf16 v[108:111], v[44:47], v[164:167], v[108:111]
    s_add_u32 s79, s79, s45
    s_add_u32 m0, m0, s80
    v_mfma_f32_16x16x32_bf16 v[116:119], v[44:47], v[196:199], v[116:119]
    buffer_load_dwordx4 v27, s[48:51], s79 offen lds
    v_mfma_f32_16x16x32_bf16 v[124:127], v[44:47], v[228:231], v[124:127]
    s_add_u32 s79, s79, s45
    s_add_u32 m0, m0, s80
    s_waitcnt lgkmcnt(10)
    v_mfma_f32_16x16x32_bf16 v[96:99], v[48:51], v[136:139], v[96:99]
    buffer_load_dwordx4 v28, s[48:51], s79 offen lds
    v_mfma_f32_16x16x32_bf16 v[104:107], v[48:51], v[168:171], v[104:107]
    s_add_u32 s79, s79, s45
    s_add_u32 m0, m0, s80
    v_mfma_f32_16x16x32_bf16 v[112:115], v[48:51], v[200:203], v[112:115]
    buffer_load_dwordx4 v29, s[48:51], s79 offen lds
    v_mfma_f32_16x16x32_bf16 v[120:123], v[48:51], v[232:235], v[120:123]
    s_add_u32 s79, s79, s45
    s_add_u32 m0, m0, s80
    v_mfma_f32_16x16x32_bf16 v[100:103], v[52:55], v[136:139], v[100:103]
    buffer_load_dwordx4 v28, s[48:51], s79 offen lds
    v_mfma_f32_16x16x32_bf16 v[108:111], v[52:55], v[168:171], v[108:111]
    s_add_u32 s79, s79, s45
    s_add_u32 m0, m0, s80
    v_mfma_f32_16x16x32_bf16 v[116:119], v[52:55], v[200:203], v[116:119]
    buffer_load_dwordx4 v29, s[48:51], s79 offen lds
    v_mfma_f32_16x16x32_bf16 v[124:127], v[52:55], v[232:235], v[124:127]
    s_add_u32 s79, s79, s45
    s_add_u32 m0, m0, s80
    s_waitcnt lgkmcnt(8)
    v_mfma_f32_16x16x32_bf16 v[96:99], v[56:59], v[140:143], v[96:99]
    buffer_load_dwordx4 v30, s[48:51], s79 offen lds
    v_mfma_f32_16x16x32_bf16 v[104:107], v[56:59], v[172:175], v[104:107]
    s_add_u32 s79, s79, s45
    s_add_u32 m0, m0, s80
    v_mfma_f32_16x16x32_bf16 v[112:115], v[56:59], v[204:207], v[112:115]
    buffer_load_dwordx4 v31, s[48:51], s79 offen lds
    v_mfma_f32_16x16x32_bf16 v[120:123], v[56:59], v[236:239], v[120:123]
    s_add_u32 s79, s79, s45
    s_add_u32 m0, m0, s80
    v_mfma_f32_16x16x32_bf16 v[100:103], v[60:63], v[140:143], v[100:103]
    buffer_load_dwordx4 v30, s[48:51], s79 offen lds
    v_mfma_f32_16x16x32_bf16 v[108:111], v[60:63], v[172:175], v[108:111]
    s_add_u32 s79, s79, s45
    s_add_u32 m0, m0, s80
    v_mfma_f32_16x16x32_bf16 v[116:119], v[60:63], v[204:207], v[116:119]
    buffer_load_dwordx4 v31, s[48:51], s79 offen lds
    v_mfma_f32_16x16x32_bf16 v[124:127], v[60:63], v[236:239], v[124:127]
    s_add_u32 s79, s79, s45
    s_add_u32 m0, m0, s80
    s_waitcnt lgkmcnt(6)
    v_mfma_f32_16x16x32_bf16 v[96:99], v[64:67], v[144:147], v[96:99]
    v_mfma_f32_16x16x32_bf16 v[104:107], v[64:67], v[176:179], v[104:107]
    v_mfma_f32_16x16x32_bf16 v[112:115], v[64:67], v[208:211], v[112:115]
    v_mfma_f32_16x16x32_bf16 v[120:123], v[64:67], v[240:243], v[120:123]
    v_mfma_f32_16x16x32_bf16 v[100:103], v[68:71], v[144:147], v[100:103]
    v_mfma_f32_16x16x32_bf16 v[108:111], v[68:71], v[176:179], v[108:111]
    v_mfma_f32_16x16x32_bf16 v[116:119], v[68:71], v[208:211], v[116:119]
    v_mfma_f32_16x16x32_bf16 v[124:127], v[68:71], v[240:243], v[124:127]
    s_waitcnt lgkmcnt(4)
    v_mfma_f32_16x16x32_bf16 v[96:99], v[72:75], v[148:151], v[96:99]
    v_mfma_f32_16x16x32_bf16 v[104:107], v[72:75], v[180:183], v[104:107]
    v_mfma_f32_16x16x32_bf16 v[112:115], v[72:75], v[212:215], v[112:115]
    v_mfma_f32_16x16x32_bf16 v[120:123], v[72:75], v[244:247], v[120:123]
    v_mfma_f32_16x16x32_bf16 v[100:103], v[76:79], v[148:151], v[100:103]
    v_mfma_f32_16x16x32_bf16 v[108:111], v[76:79], v[180:183], v[108:111]
    v_mfma_f32_16x16x32_bf16 v[116:119], v[76:79], v[212:215], v[116:119]
    v_mfma_f32_16x16x32_bf16 v[124:127], v[76:79], v[244:247], v[124:127]
    s_waitcnt lgkmcnt(2)
    v_mfma_f32_16x16x32_bf16 v[96:99], v[80:83], v[152:155], v[96:99]
    v_mfma_f32_16x16x32_bf16 v[104:107], v[80:83], v[184:187], v[104:107]
    v_mfma_f32_16x16x32_bf16 v[112:115], v[80:83], v[216:219], v[112:115]
    v_mfma_f32_16x16x32_bf16 v[120:123], v[80:83], v[248:251], v[120:123]
    v_mfma_f32_16x16x32_bf16 v[100:103], v[84:87], v[152:155], v[100:103]
    v_mfma_f32_16x16x32_bf16 v[108:111], v[84:87], v[184:187], v[108:111]
    v_mfma_f32_16x16x32_bf16 v[116:119], v[84:87], v[216:219], v[116:119]
    v_mfma_f32_16x16x32_bf16 v[124:127], v[84:87], v[248:251], v[124:127]
    s_waitcnt lgkmcnt(0)
    v_mfma_f32_16x16x32_bf16 v[96:99], v[88:91], v[156:159], v[96:99]
    v_mfma_f32_16x16x32_bf16 v[104:107], v[88:91], v[188:191], v[104:107]
    v_mfma_f32_16x16x32_bf16 v[112:115], v[88:91], v[220:223], v[112:115]
    v_mfma_f32_16x16x32_bf16 v[120:123], v[88:91], v[252:255], v[120:123]
    v_mfma_f32_16x16x32_bf16 v[100:103], v[92:95], v[156:159], v[100:103]
    v_mfma_f32_16x16x32_bf16 v[108:111], v[92:95], v[188:191], v[108:111]
    v_mfma_f32_16x16x32_bf16 v[116:119], v[92:95], v[220:223], v[116:119]
    v_mfma_f32_16x16x32_bf16 v[124:127], v[92:95], v[252:255], v[124:127]
    v_xor_b32 v8, 65536, v8
    v_xor_b32 v9, 65536, v9
    v_xor_b32 v10, 65536, v10
    v_xor_b32 v11, 65536, v11
    s_nop 1
    s_movk_i32 s81, 14336
    s_nop 2
    v_mul_f32 v96, s86, v96
    v_mul_f32 v97, s86, v97
    v_mul_f32 v98, s86, v98
    v_mul_f32 v99, s86, v99
    v_mul_f32 v100, s86, v100
    v_mul_f32 v101, s86, v101
    v_mul_f32 v102, s86, v102
    v_mul_f32 v103, s86, v103
    v_cvt_pk_bf16_f32 v32, v96, v97
    v_cvt_pk_bf16_f32 v33, v98, v99
    v_cvt_pk_bf16_f32 v34, v100, v101
    v_cvt_pk_bf16_f32 v35, v102, v103
    buffer_store_dwordx4 v[32:35], v6, s[16:19], s82 offen sc1
    s_add_u32 s82, s82, s81
    v_mul_f32 v104, s86, v104
    v_mul_f32 v105, s86, v105
    v_mul_f32 v106, s86, v106
    v_mul_f32 v107, s86, v107
    v_mul_f32 v108, s86, v108
    v_mul_f32 v109, s86, v109
    v_mul_f32 v110, s86, v110
    v_mul_f32 v111, s86, v111
    v_cvt_pk_bf16_f32 v36, v104, v105
    v_cvt_pk_bf16_f32 v37, v106, v107
    v_cvt_pk_bf16_f32 v38, v108, v109
    v_cvt_pk_bf16_f32 v39, v110, v111
    buffer_store_dwordx4 v[36:39], v6, s[16:19], s82 offen sc1
    s_add_u32 s82, s82, s81
    v_mul_f32 v112, s86, v112
    v_mul_f32 v113, s86, v113
    v_mul_f32 v114, s86, v114
    v_mul_f32 v115, s86, v115
    v_mul_f32 v116, s86, v116
    v_mul_f32 v117, s86, v117
    v_mul_f32 v118, s86, v118
    v_mul_f32 v119, s86, v119
    v_cvt_pk_bf16_f32 v40, v112, v113
    v_cvt_pk_bf16_f32 v41, v114, v115
    v_cvt_pk_bf16_f32 v42, v116, v117
    v_cvt_pk_bf16_f32 v43, v118, v119
    buffer_store_dwordx4 v[40:43], v6, s[16:19], s82 offen sc1
    s_add_u32 s82, s82, s81
    v_mul_f32 v120, s86, v120
    v_mul_f32 v121, s86, v121
    v_mul_f32 v122, s86, v122
    v_mul_f32 v123, s86, v123
    v_mul_f32 v124, s86, v124
    v_mul_f32 v125, s86, v125
    v_mul_f32 v126, s86, v126
    v_mul_f32 v127, s86, v127
    v_cvt_pk_bf16_f32 v44, v120, v121
    v_cvt_pk_bf16_f32 v45, v122, v123
    v_cvt_pk_bf16_f32 v46, v124, v125
    v_cvt_pk_bf16_f32 v47, v126, v127
    buffer_store_dwordx4 v[44:47], v6, s[16:19], s82 offen sc1
    s_add_u32 s82, s82, s81
    s_sub_u32 s88, s88, 1
    s_cmp_lg_u32 s88, 0
    s_cbranch_scc1 P_blk
    s_cmp_lg_u32 s78, 0
    s_cbranch_scc1 P_done
    s_mov_b32 s78, 1
    s_mov_b32 s47, 1
    s_cmp_eq_u32 s28, 0
    s_cselect_b32 s88, 1, 2
    s_add_u32 s84, s84, 6422528
    s_mov_b32 s86, 1.0
    s_mov_b32 s81, 0x05040100
    s_mov_b32 s82, 0x07060302
    v_xor_b32 v22, 32, v20
    s_waitcnt vmcnt(20)
    v_accvgpr_read_b32 v12, a0
    v_accvgpr_read_b32 v13, a1
    v_accvgpr_read_b32 v14, a2
    v_accvgpr_read_b32 v15, a3
    v_perm_b32 v16, v13, v12, s81
    v_perm_b32 v17, v15, v14, s81
    v_perm_b32 v18, v13, v12, s82
    v_perm_b32 v19, v15, v14, s82
    ds_write_b64 v20, v[16:17] offset:0
    ds_write_b64 v22, v[18:19] offset:0
    v_xor_b32 v20, 64, v20
    v_xor_b32 v22, 64, v22
    v_accvgpr_read_b32 v12, a4
    v_accvgpr_read_b32 v13, a5
    v_accvgpr_read_b32 v14, a6
    v_accvgpr_read_b32 v15, a7
    v_perm_b32 v16, v13, v12, s81
    v_perm_b32 v17, v15, v14, s81
    v_perm_b32 v18, v13, v12, s82
    v_perm_b32 v19, v15, v14, s82
    ds_write_b64 v20, v[16:17] offset:1024
    ds_write_b64 v22, v[18:19] offset:1024
    v_xor_b32 v20, 64, v20
    v_xor_b32 v22, 64, v22
    v_accvgpr_read_b32 v12, a8
    v_accvgpr_read_b32 v13, a9
    v_accvgpr_read_b32 v14, a10
    v_accvgpr_read_b32 v15, a11
    v_perm_b32 v16, v13, v12, s81
    v_perm_b32 v17, v15, v14, s81
    v_perm_b32 v18, v13, v12, s82
    v_perm_b32 v19, v15, v14, s82
    ds_write_b64 v20, v[16:17] offset:2048
    ds_write_b64 v22, v[18:19] offset:2048
    v_xor_b32 v20, 64, v20
    v_xor_b32 v22, 64, v22
    v_accvgpr_read_b32 v12, a12
    v_accvgpr_read_b32 v13, a13
    v_accvgpr_read_b32 v14, a14
    v_accvgpr_read_b32 v15, a15
    v_perm_b32 v16, v13, v12, s81
    v_perm_b32 v17, v15, v14, s81
    v_perm_b32 v18, v13, v12, s82
    v_perm_b32 v19, v15, v14, s82
    ds_write_b64 v20, v[16:17] offset:3072
    ds_write_b64 v22, v[18:19] offset:3072
    v_xor_b32 v20, 64, v20
    v_xor_b32 v22, 64, v22
    v_accvgpr_read_b32 v12, a16
    v_accvgpr_read_b32 v13, a17
    v_accvgpr_read_b32 v14, a18
    v_accvgpr_read_b32 v15, a19
    v_perm_b32 v16, v13, v12, s81
    v_perm_b32 v17, v15, v14, s81
    v_perm_b32 v18, v13, v12, s82
    v_perm_b32 v19, v15, v14, s82
    ds_write_b64 v20, v[16:17] offset:4096
    ds_write_b64 v22, v[18:19] offset:4096
    v_xor_b32 v20, 64, v20
    v_xor_b32 v22, 64, v22
    v_accvgpr_read_b32 v12, a20
    v_accvgpr_read_b32 v13, a21
    v_accvgpr_read_b32 v14, a22
    v_accvgpr_read_b32 v15, a23
    v_perm_b32 v16, v13, v12, s81
    v_perm_b32 v17, v15, v14, s81
    v_perm_b32 v18, v13, v12, s82
    v_perm_b32 v19, v15, v14, s82
    ds_write_b64 v20, v[16:17] offset:5120
    ds_write_b64 v22, v[18:19] offset:5120
    v_xor_b32 v20, 64, v20
    v_xor_b32 v22, 64, v22
    v_accvgpr_read_b32 v12, a24
    v_accvgpr_read_b32 v13, a25
    v_accvgpr_read_b32 v14, a26
    v_accvgpr_read_b32 v15, a27
    v_perm_b32 v16, v13, v12, s81
    v_perm_b32 v17, v15, v14, s81
    v_perm_b32 v18, v13, v12, s82
    v_perm_b32 v19, v15, v14, s82
    ds_write_b64 v20, v[16:17] offset:6144
    ds_write_b64 v22, v[18:19] offset:6144
    v_xor_b32 v20, 64, v20
    v_xor_b32 v22, 64, v22
    v_accvgpr_read_b32 v12, a28
    v_accvgpr_read_b32 v13, a29
    v_accvgpr_read_b32 v14, a30
    v_accvgpr_read_b32 v15, a31
    v_perm_b32 v16, v13, v12, s81
    v_perm_b32 v17, v15, v14, s81
    v_perm_b32 v18, v13, v12, s82
    v_perm_b32 v19, v15, v14, s82
    ds_write_b64 v20, v[16:17] offset:7168
    ds_write_b64 v22, v[18:19] offset:7168
    v_xor_b32 v20, 64, v20
    v_xor_b32 v22, 64, v22
    v_xor_b32 v22, 32, v21
    v_xor_b32 v23, 64, v21
    v_xor_b32 v20, 0x60, v21
    s_waitcnt lgkmcnt(0)
    s_barrier
    ds_read_b64_tr_b16 v[128:129], v21 offset:0
    ds_read_b64_tr_b16 v[130:131], v21 offset:512
    ds_read_b64_tr_b16 v[132:133], v21 offset:4096
    ds_read_b64_tr_b16 v[134:135], v21 offset:4608
    ds_read_b64_tr_b16 v[136:137], v21 offset:8192
    ds_read_b64_tr_b16 v[138:139], v21 offset:8704
    ds_read_b64_tr_b16 v[140:141], v21 offset:12288
    ds_read_b64_tr_b16 v[142:143], v21 offset:12800
    ds_read_b64_tr_b16 v[144:145], v21 offset:16384
    ds_read_b64_tr_b16 v[146:147], v21 offset:16896
    ds_read_b64_tr_b16 v[148:149], v21 offset:20480
    ds_read_b64_tr_b16 v[150:151], v21 offset:20992
    ds_read_b64_tr_b16 v[152:153], v21 offset:24576
    ds_read_b64_tr_b16 v[154:155], v21 offset:25088
    ds_read_b64_tr_b16 v[156:157], v21 offset:28672
    ds_read_b64_tr_b16 v[158:159], v21 offset:29184
    ds_read_b64_tr_b16 v[160:161], v22 offset:0
    ds_read_b64_tr_b16 v[162:163], v22 offset:512
    ds_read_b64_tr_b16 v[164:165], v22 offset:4096
    ds_read_b64_tr_b16 v[166:167], v22 offset:4608
    ds_read_b64_tr_b16 v[168:169], v22 offset:8192
    ds_read_b64_tr_b16 v[170:171], v22 offset:8704
    ds_read_b64_tr_b16 v[172:173], v22 offset:12288
    ds_read_b64_tr_b16 v[174:175], v22 offset:12800
    ds_read_b64_tr_b16 v[176:177], v22 offset:16384
    ds_read_b64_tr_b16 v[178:179], v22 offset:16896
    ds_read_b64_tr_b16 v[180:181], v22 offset:20480
    ds_read_b64_tr_b16 v[182:183], v22 offset:20992
    ds_read_b64_tr_b16 v[184:185], v22 offset:24576
    ds_read_b64_tr_b16 v[186:187], v22 offset:25088
    ds_read_b64_tr_b16 v[188:189], v22 offset:28672
    ds_read_b64_tr_b16 v[190:191], v22 offset:29184
    ds_read_b64_tr_b16 v[192:193], v23 offset:0
    ds_read_b64_tr_b16 v[194:195], v23 offset:512
    ds_read_b64_tr_b16 v[196:197], v23 offset:4096
    ds_read_b64_tr_b16 v[198:199], v23 offset:4608
    ds_read_b64_tr_b16 v[200:201], v23 offset:8192
    ds_read_b64_tr_b16 v[202:203], v23 offset:8704
    ds_read_b64_tr_b16 v[204:205], v23 offset:12288
    ds_read_b64_tr_b16 v[206:207], v23 offset:12800
    ds_read_b64_tr_b16 v[208:209], v23 offset:16384
    ds_read_b64_tr_b16 v[210:211], v23 offset:16896
    ds_read_b64_tr_b16 v[212:213], v23 offset:20480
    ds_read_b64_tr_b16 v[214:215], v23 offset:20992
    ds_read_b64_tr_b16 v[216:217], v23 offset:24576
    ds_read_b64_tr_b16 v[218:219], v23 offset:25088
    ds_read_b64_tr_b16 v[220:221], v23 offset:28672
    ds_read_b64_tr_b16 v[222:223], v23 offset:29184
    ds_read_b64_tr_b16 v[224:225], v20 offset:0
    ds_read_b64_tr_b16 v[226:227], v20 offset:512
    ds_read_b64_tr_b16 v[228:229], v20 offset:4096
    ds_read_b64_tr_b16 v[230:231], v20 offset:4608
    ds_read_b64_tr_b16 v[232:233], v20 offset:8192
    ds_read_b64_tr_b16 v[234:235], v20 offset:8704
    ds_read_b64_tr_b16 v[236:237], v20 offset:12288
    ds_read_b64_tr_b16 v[238:239], v20 offset:12800
    ds_read_b64_tr_b16 v[240:241], v20 offset:16384
    ds_read_b64_tr_b16 v[242:243], v20 offset:16896
    ds_read_b64_tr_b16 v[244:245], v20 offset:20480
    ds_read_b64_tr_b16 v[246:247], v20 offset:20992
    ds_read_b64_tr_b16 v[248:249], v20 offset:24576
    ds_read_b64_tr_b16 v[250:251], v20 offset:25088
    ds_read_b64_tr_b16 v[252:253], v20 offset:28672
    ds_read_b64_tr_b16 v[254:255], v20 offset:29184
    s_lshl2_add_u32 s79, s28, s89
    s_add_u32 s79, s79, 95125504
    v_mov_b32 v4, 0
    s_waitcnt vmcnt(0)
    s_mov_b64 exec, 1
    buffer_store_dword v5, v4, s[16:19], s79 offen sc1
    s_mov_b64 exec, -1
    s_branch P_blk
P_done:
    s_add_u32 s89, s89, 16
    s_branch L_unit_done
L_unit_misc:
    v_and_b32 v1, 63, v0
    v_lshrrev_b32 v2, 4, v1
    v_and_b32 v3, 15, v1
    v_lshlrev_b32 v4, 4, v1
    s_lshl2_add_u32 s86, s42, s28
    s_mul_i32 s78, s86, 14336
    s_mul_i32 m0, s28, 14592
    s_mov_b32 exec_hi, 0x00ffffff
    s_mov_b32 s85, 16
M_lx:
    buffer_load_dwordx4 v4, s[20:23], s78 offen lds
    s_add_u32 s78, s78, 896
    s_add_u32 m0, m0, 912
    s_sub_u32 s85, s85, 1
    s_cmp_lg_u32 s85, 0
    s_cbranch_scc1 M_lx
    s_cmp_eq_u32 s28, 0
    s_cselect_b32 s48, s74, s76
    s_cselect_b32 s49, s75, s77
    s_mov_b32 s50, 896
    s_mov_b32 s51, 0x20000
    s_cselect_b32 s78, 0, 1024
    s_add_u32 m0, s78, 65536
    s_nop 0
    buffer_load_dwordx4 v4, s[48:51], 0 offen lds
    s_mov_b64 exec, -1
    v_mov_b32 v8, -1
    v_mov_b32 v9, -1
    v_mov_b32 v10, -1
    v_mov_b32 v11, -1
    s_lshl_b32 s78, s86, 10
    s_add_u32 s79, s78, 71572480
    s_cmp_eq_u32 s44, 0
    s_cbranch_scc0 M_s1b
M_s1:
    buffer_store_dwordx4 v[8:11], v4, s[16:19], s79 offen
    s_add_u32 s79, s79, 131072
    s_cmp_lt_u32 s79, 72810496
    s_cbranch_scc1 M_s1
    s_branch M_s1e
M_s1b:
    buffer_store_dwordx4 v[8:11], v4, s[16:19], s79 offen sc1
    s_add_u32 s79, s79, 131072
    s_cmp_lt_u32 s79, 72810496
    s_cbranch_scc1 M_s1b
M_s1e:
    s_add_u32 s79, s78, 72817664
M_s2:
    buffer_store_dwordx4 v[8:11], v4, s[16:19], s79 offen sc1
    s_add_u32 s79, s79, 131072
    s_cmp_lt_u32 s79, 73269248
    s_cbranch_scc1 M_s2
    v_mov_b32 v12, 0
    v_lshlrev_b32 v13, 2, v1
    s_lshl_b32 s80, s86, 7
    s_add_u32 s80, s80, 73269248
    s_mov_b32 exec_hi, 0
    buffer_store_dword v12, v13, s[16:19], s80 offen sc1
    s_mov_b64 exec, -1
    s_cmp_ge_u32 s42, 7
    s_cbranch_scc1 P_nomem
    s_mov_b32 s52, s60
    s_mov_b32 s53, s61
    s_mov_b32 s54, 7168
    s_mov_b32 s55, 0x20000
    v_bfe_u32 v12, v1, 1, 3
    v_mul_u32_u24 v12, 896, v12
    v_lshl_add_u32 v12, v2, 5, v12
    v_and_b32 v14, 1, v1
    v_lshl_add_u32 v12, v14, 2, v12
    s_lshl_b32 s78, s42, 7
    s_lshl3_add_u32 s78, s28, s78
    s_lshl_b32 s79, s28, 2
    v_add_u32 v14, s79, v4
    buffer_load_dword v16, v12, s[52:55], s78 offen
    s_lshl_b32 s79, s42, 10
    s_add_u32 s79, s79, 71565312
    s_add_u32 s80, s79, 1245184
    s_waitcnt vmcnt(0)
    buffer_store_dword v16, v14, s[16:19], s79 offen sc1
    buffer_store_dword v16, v14, s[16:19], s80 offen sc1
P_nomem:
    s_waitcnt vmcnt(13)
    s_barrier
    s_and_b32 s82, s28, 1
    s_mul_i32 s78, s28, 7
    s_add_u32 s83, s78, s82
    s_lshr_b32 s83, s83, 1
    s_add_u32 s79, s78, 6
    s_cmp_eq_u32 s82, 1
    s_cselect_b32 s84, s78, s79
    s_lshr_b32 s84, s84, 1
    v_and_b32 v20, 1, v2
    v_lshrrev_b32 v21, 1, v2
    v_cmp_eq_u32 vcc, 1, v20
    v_add_u32 v22, s83, v20
    s_add_u32 s78, s83, 2
    v_mov_b32 v23, s78
    v_mov_b32 v24, s84
    v_cndmask_b32 v23, v23, v24, vcc
    s_sub_u32 s78, s82, 1
    s_not_b32 s79, s78
    v_mov_b32 v24, s78
    v_cndmask_b32 v30, -1, v24, vcc
    v_mov_b32 v24, s79
    v_cndmask_b32 v31, -1, v24, vcc
    v_mov_b32 v28, -1
    v_mov_b32 v29, -1
    v_bfe_u32 v25, v3, 1, 1
    v_lshlrev_b32 v25, 4, v25
    v_lshrrev_b32 v26, 2, v3
    v_lshl_add_u32 v25, v26, 2, v25
    v_and_b32 v26, 1, v3
    v_lshl_add_u32 v25, v26, 1, v25
    v_mul_u32_u24 v25, 912, v25
    v_lshl_add_u32 v25, v21, 4, v25
    v_lshl_add_u32 v6, v22, 6, v25
    v_lshl_add_u32 v7, v23, 6, v25
    s_mul_i32 s78, s42, 65536
    s_lshl_b32 s79, s28, 13
    s_add_u32 s78, s78, s79
    s_add_u32 s78, s78, 73285632
    s_mov_b32 s79, 4096
    s_mov_b32 s85, 4
M_xk:
    ds_read2_b32 v[32:33], v6 offset0:0 offset1:2
    ds_read2_b32 v[34:35], v6 offset0:1 offset1:3
    ds_read2_b32 v[36:37], v6 offset0:8 offset1:10
    ds_read2_b32 v[38:39], v6 offset0:9 offset1:11
    ds_read2_b32 v[40:41], v6 offset0:228 offset1:230
    ds_read2_b32 v[42:43], v6 offset0:229 offset1:231
    ds_read2_b32 v[44:45], v6 offset0:236 offset1:238
    ds_read2_b32 v[46:47], v6 offset0:237 offset1:239
    v_add_u32 v6, 29184, v6
    v_swap_b32 v6, v7
    s_waitcnt lgkmcnt(0)
    v_and_b32 v32, v32, v28
    v_and_b32 v33, v33, v29
    v_and_b32 v34, v34, v28
    v_and_b32 v35, v35, v29
    v_and_b32 v36, v36, v28
    v_and_b32 v37, v37, v29
    v_and_b32 v38, v38, v28
    v_and_b32 v39, v39, v29
    v_and_b32 v40, v40, v28
    v_and_b32 v41, v41, v29
    v_and_b32 v42, v42, v28
    v_and_b32 v43, v43, v29
    v_and_b32 v44, v44, v28
    v_and_b32 v45, v45, v29
    v_and_b32 v46, v46, v28
    v_and_b32 v47, v47, v29
    v_swap_b32 v28, v30
    v_swap_b32 v29, v31
    s_cmp_eq_u32 s44, 0
    s_cbranch_scc0 M_xkb
    buffer_store_dwordx4 v[32:35], v4, s[16:19], s78 offen offset:0
    buffer_store_dwordx4 v[36:39], v4, s[16:19], s78 offen offset:1024
    buffer_store_dwordx4 v[40:43], v4, s[16:19], s78 offen offset:2048
    buffer_store_dwordx4 v[44:47], v4, s[16:19], s78 offen offset:3072
    s_branch M_xke
M_xkb:
    buffer_store_dwordx4 v[32:35], v4, s[16:19], s78 offen offset:0 sc1
    buffer_store_dwordx4 v[36:39], v4, s[16:19], s78 offen offset:1024 sc1
    buffer_store_dwordx4 v[40:43], v4, s[16:19], s78 offen offset:2048 sc1
    buffer_store_dwordx4 v[44:47], v4, s[16:19], s78 offen offset:3072 sc1
M_xke:
    s_add_u32 s78, s78, s79
    s_sub_u32 s79, 32768, s79
    s_sub_u32 s85, s85, 1
    s_cmp_lg_u32 s85, 0
    s_cbranch_scc1 M_xk
    s_waitcnt vmcnt(0)
    s_barrier
    s_cmp_lg_u32 s28, 0
    s_cbranch_scc1 M_ka
    v_accvgpr_read_b32 v5, a254
    s_lshl_b32 s78, s42, 6
    s_add_u32 s78, s78, 95139860
    v_mov_b32 v2, 0
    v_add_u32 v5, 1, v5
    s_mov_b64 exec, 1
    buffer_store_dword v5, v2, s[16:19], s78 offen sc1
    s_mov_b64 exec, -1
M_ka:
    v_lshrrev_b32 v2, 4, v1
    s_lshl_b32 s78, s28, 4
    v_add_u32 v6, s78, v3
    v_mul_u32_u24 v6, 912, v6
    v_lshl_add_u32 v6, v2, 4, v6
    v_lshlrev_b32 v7, 4, v2
    v_add_u32 v7, 65536, v7
    s_mul_i32 s78, s86, 14336
    s_add_u32 s78, s78, 75382784
    v_mov_b32 v8, 0
    v_mov_b32 v9, 0
    s_mov_b32 s85, 14
M_xf:
    ds_read_b128 v[16:19], v6
    ds_read_b128 v[20:23], v7
    ds_read_b128 v[24:27], v7 offset:1024
    v_add_u32 v6, 64, v6
    v_add_u32 v7, 64, v7
    s_waitcnt lgkmcnt(0)
    buffer_store_dwordx4 v[16:19], v4, s[16:19], s78 offen sc1
    v_dot2_f32_bf16 v8, v16, v20, v8
    v_dot2_f32_bf16 v9, v16, v24, v9
    v_dot2_f32_bf16 v8, v17, v21, v8
    v_dot2_f32_bf16 v9, v17, v25, v9
    v_dot2_f32_bf16 v8, v18, v22, v8
    v_dot2_f32_bf16 v9, v18, v26, v9
    v_dot2_f32_bf16 v8, v19, v23, v8
    v_dot2_f32_bf16 v9, v19, v27, v9
    s_add_u32 s78, s78, 1024
    s_sub_u32 s85, s85, 1
    s_cmp_lg_u32 s85, 0
    s_cbranch_scc1 M_xf
    v_mov_b32 v10, v8
    v_mov_b32 v11, v9
    s_nop 0
    v_permlane16_swap_b32 v8, v10
    v_permlane16_swap_b32 v9, v11
    v_add_f32 v8, v8, v10
    v_add_f32 v9, v9, v11
    v_mov_b32 v10, v8
    v_mov_b32 v11, v9
    s_nop 0
    v_permlane32_swap_b32 v8, v10
    v_permlane32_swap_b32 v9, v11
    v_add_f32 v8, v8, v10
    v_add_f32 v9, v9, v11
    v_cvt_pk_bf16_f32 v9, v9, v9
    v_and_b32 v9, 0xffff0000, v9
    v_mul_f32 v9, 0xbfb8aa3b, v9
    v_exp_f32 v9, v9
    s_nop 0
    v_add_f32 v9, 1.0, v9
    v_rcp_f32 v9, v9
    s_nop 0
    v_cvt_pk_bf16_f32 v9, v9, v9
    v_and_b32 v9, 0xffff0000, v9
    s_lshl_b32 s80, s86, 6
    s_add_u32 s80, s80, 77217792
    s_mov_b64 exec, 0xffff
    buffer_store_dword v8, v13, s[16:19], s80 offen sc1
    s_add_u32 s80, s80, 8192
    buffer_store_dword v9, v13, s[16:19], s80 offen sc1
    s_mov_b64 exec, -1
    s_lshl_b32 s89, s42, 6
    s_add_u32 s89, s89, 14352
L_unit_done:
    s_waitcnt vmcnt(0)
    v_accvgpr_read_b32 v3, a254
    v_add_u32 v3, 1, v3
    s_barrier
    v_readfirstlane_b32 s59, v3
    s_cmp_lg_u32 s28, 0
    s_cbranch_scc1 L_elect_wait
    v_mov_b32 v2, s89
    s_mov_b32 s41, 95125504
    s_mov_b64 exec, 1
    buffer_store_dword v3, v2, s[16:19], s41 offen sc1
    s_mov_b64 exec, -1
    v_accvgpr_read_b32 v3, a255
    s_nop 0
    v_readfirstlane_b32 s43, v3
    s_lshl_b32 s29, s44, 5
    s_add_u32 s29, s29, s43
    s_cmp_lt_u32 s43, 32
    s_cselect_b32 s41, s44, 99
    s_cmp_lt_u32 s41, 8
    s_cbranch_scc0 L_overflow
L_elect_done:
    v_mov_b32 v2, 0
    v_mov_b32 v3, s29
    ds_write_b32 v2, v3
    s_waitcnt lgkmcnt(0)
L_elect_wait:
    s_barrier
    v_mov_b32 v2, 0
    ds_read_b32 v3, v2
    s_waitcnt lgkmcnt(0)
    v_readfirstlane_b32 s29, v3
    s_barrier
    s_cmp_lt_u32 s29, 16
    s_cbranch_scc1 L_role_T
    s_cmp_lt_u32 s29, 30
    s_cbranch_scc1 L_role_V
    s_cmp_lt_u32 s29, 32
    s_cbranch_scc1 L_role_W
    s_cmp_ge_u32 s29, 256
    s_cbranch_scc1 L_exit
    s_sub_u32 s36, s29, 32
    s_mul_i32 s34, s36, 4682
    s_lshr_b32 s34, s34, 16
    s_mul_i32 s41, s34, 14
    s_sub_u32 s35, s36, s41
    s_lshl_b32 s37, s36, 6
    s_add_u32 s37, s37, 73269248
    s_mov_b32 s31, 200000
    v_and_b32 v1, 63, v0
    v_lshrrev_b32 v2, 4, v1
    v_and_b32 v3, 15, v1
    v_lshlrev_b32 v4, 4, v1
    v_and_b32 v8, 1, v0
    v_cmp_eq_u32 vcc, 0, v8
    v_mov_b32 v8, 0xEEEE
    v_mov_b32 v9, 0x4444
    v_cndmask_b32 v5, v8, v9, vcc
    s_mul_i32 s41, s34, 28
    s_lshl_b32 s42, s35, 1
    s_add_u32 s41, s41, s42
    s_mul_i32 s41, s41, 14336
    s_add_u32 s42, s41, 6422528
    s_mov_b32 s45, s41
    s_cmp_lg_u32 s28, 0
    s_cbranch_scc1 fld_2
    v_mov_b32 v8, 16512
    s_mov_b32 s32, 200000
    s_mov_b32 s41, 95125504
fl_1:
    buffer_load_dword v9, v8, s[16:19], s41 offen sc1
    s_waitcnt vmcnt(0)
    v_cmp_eq_u32 vcc, s59, v9
    s_nop 0
    s_cmp_eq_u64 vcc, -1
    s_cbranch_scc1 fld_2
    s_sleep 8
    s_sub_u32 s32, s32, 1
    s_cmp_lg_u32 s32, 0
    s_cbranch_scc1 fl_1
fld_2:
    s_barrier
    s_mov_b32 s41, s45
    s_mul_i32 s43, s28, 14336
    s_mov_b32 m0, s43
    s_add_u32 s42, s42, s43
    s_add_u32 s41, s41, s43
    s_sub_u32 s41, s41, 28672
    s_cmp_lt_u32 s28, 2
    s_cselect_b32 s41, s42, s41
    s_mov_b32 s42, 14
H_wl:
    buffer_load_dwordx4 v4, s[16:19], s41 offen sc1 lds
    s_add_u32 s41, s41, 1024
    s_add_u32 m0, m0, 1024
    s_sub_u32 s42, s42, 1
    s_cmp_lg_u32 s42, 0
    s_cbranch_scc1 H_wl
    s_mul_i32 s45, s28, 28672
    s_add_u32 s45, s45, 75382784
    s_add_u32 s43, s45, 0
    buffer_load_dwordx4 v[32:35], v4, s[16:19], s43 offen offset:0 sc1
    s_add_u32 s43, s45, 12288
    buffer_load_dwordx4 v[36:39], v4, s[16:19], s43 offen offset:2048 sc1
    s_add_u32 s43, s45, 0
    buffer_load_dwordx4 v[40:43], v4, s[16:19], s43 offen offset:1024 sc1
    s_add_u32 s43, s45, 12288
    buffer_load_dwordx4 v[44:47], v4, s[16:19], s43 offen offset:3072 sc1
    s_add_u32 s43, s45, 0
    buffer_load_dwordx4 v[48:51], v4, s[16:19], s43 offen offset:2048 sc1
    s_add_u32 s43, s45, 16384
    buffer_load_dwordx4 v[52:55], v4, s[16:19], s43 offen offset:0 sc1
    s_add_u32 s43, s45, 0
    buffer_load_dwordx4 v[56:59], v4, s[16:19], s43 offen offset:3072 sc1
    s_add_u32 s43, s45, 16384
    buffer_load_dwordx4 v[60:63], v4, s[16:19], s43 offen offset:1024 sc1
    s_add_u32 s43, s45, 4096
    buffer_load_dwordx4 v[64:67], v4, s[16:19], s43 offen offset:0 sc1
    s_add_u32 s43, s45, 16384
    buffer_load_dwordx4 v[68:71], v4, s[16:19], s43 offen offset:2048 sc1
    s_add_u32 s43, s45, 4096
    buffer_load_dwordx4 v[72:75], v4, s[16:19], s43 offen offset:1024 sc1
    s_add_u32 s43, s45, 16384
    buffer_load_dwordx4 v[76:79], v4, s[16:19], s43 offen offset:3072 sc1
    s_add_u32 s43, s45, 4096
    buffer_load_dwordx4 v[80:83], v4, s[16:19], s43 offen offset:2048 sc1
    s_add_u32 s43, s45, 20480
    buffer_load_dwordx4 v[84:87], v4, s[16:19], s43 offen offset:0 sc1
    s_add_u32 s43, s45, 4096
    buffer_load_dwordx4 v[88:91], v4, s[16:19], s43 offen offset:3072 sc1
    s_add_u32 s43, s45, 20480
    buffer_load_dwordx4 v[92:95], v4, s[16:19], s43 offen offset:1024 sc1
    s_add_u32 s43, s45, 8192
    buffer_load_dwordx4 v[96:99], v4, s[16:19], s43 offen offset:0 sc1
    s_add_u32 s43, s45, 20480
    buffer_load_dwordx4 v[100:103], v4, s[16:19], s43 offen offset:2048 sc1
    s_add_u32 s43, s45, 8192
    buffer_load_dwordx4 v[104:107], v4, s[16:19], s43 offen offset:1024 sc1
    s_add_u32 s43, s45, 20480
    buffer_load_dwordx4 v[108:111], v4, s[16:19], s43 offen offset:3072 sc1
    s_add_u32 s43, s45, 8192
    buffer_load_dwordx4 v[112:115], v4, s[16:19], s43 offen offset:2048 sc1
    s_add_u32 s43, s45, 24576
    buffer_load_dwordx4 v[116:119], v4, s[16:19], s43 offen offset:0 sc1
    s_add_u32 s43, s45, 8192
    buffer_load_dwordx4 v[120:123], v4, s[16:19], s43 offen offset:3072 sc1
    s_add_u32 s43, s45, 24576
    buffer_load_dwordx4 v[124:127], v4, s[16:19], s43 offen offset:1024 sc1
    s_add_u32 s43, s45, 12288
    buffer_load_dwordx4 v[128:131], v4, s[16:19], s43 offen offset:0 sc1
    s_add_u32 s43, s45, 24576
    buffer_load_dwordx4 v[132:135], v4, s[16:19], s43 offen offset:2048 sc1
    s_add_u32 s43, s45, 12288
    buffer_load_dwordx4 v[136:139], v4, s[16:19], s43 offen offset:1024 sc1
    s_add_u32 s43, s45, 24576
    buffer_load_dwordx4 v[140:143], v4, s[16:19], s43 offen offset:3072 sc1
    s_and_b32 s43, s36, 31
    s_lshl2_add_u32 s43, s43, s28
    s_mul_i32 s43, s43, 14336
    s_add_u32 s43, s43, 75382784
    v_lshlrev_b32 v12, 7, v1
    buffer_load_dword v13, v12, s[16:19], s43 offen sc1
    s_add_u32 s43, s43, 6144
    buffer_load_dword v14, v12, s[16:19], s43 offen sc1
    s_waitcnt vmcnt(30)
    s_barrier
    ds_read_b128 a[0:3], v4 offset:0
    ds_read_b128 a[4:7], v4 offset:1024
    ds_read_b128 a[8:11], v4 offset:2048
    ds_read_b128 a[12:15], v4 offset:3072
    ds_read_b128 a[16:19], v4 offset:4096
    ds_read_b128 a[20:23], v4 offset:5120
    ds_read_b128 a[24:27], v4 offset:6144
    ds_read_b128 a[28:31], v4 offset:7168
    ds_read_b128 a[32:35], v4 offset:8192
    ds_read_b128 a[36:39], v4 offset:9216
    ds_read_b128 a[40:43], v4 offset:10240
    ds_read_b128 a[44:47], v4 offset:11264
    ds_read_b128 a[48:51], v4 offset:12288
    ds_read_b128 a[52:55], v4 offset:13312
    ds_read_b128 a[56:59], v4 offset:14336
    ds_read_b128 a[60:63], v4 offset:15360
    ds_read_b128 a[64:67], v4 offset:16384
    ds_read_b128 a[68:71], v4 offset:17408
    ds_read_b128 a[72:75], v4 offset:18432
    ds_read_b128 a[76:79], v4 offset:19456
    ds_read_b128 a[80:83], v4 offset:20480
    ds_read_b128 a[84:87], v4 offset:21504
    ds_read_b128 a[88:91], v4 offset:22528
    ds_read_b128 a[92:95], v4 offset:23552
    ds_read_b128 a[96:99], v4 offset:24576
    ds_read_b128 a[100:103], v4 offset:25600
    ds_read_b128 a[104:107], v4 offset:26624
    ds_read_b128 a[108:111], v4 offset:27648
    ds_read_b128 a[112:115], v4 offset:28672
    ds_read_b128 a[116:119], v4 offset:29696
    ds_read_b128 a[120:123], v4 offset:30720
    ds_read_b128 a[124:127], v4 offset:31744
    ds_read_b128 a[128:131], v4 offset:32768
    ds_read_b128 a[132:135], v4 offset:33792
    ds_read_b128 a[136:139], v4 offset:34816
    ds_read_b128 a[140:143], v4 offset:35840
    ds_read_b128 a[144:147], v4 offset:36864
    ds_read_b128 a[148:151], v4 offset:37888
    ds_read_b128 a[152:155], v4 offset:38912
    ds_read_b128 a[156:159], v4 offset:39936
    ds_read_b128 a[160:163], v4 offset:40960
    ds_read_b128 a[164:167], v4 offset:41984
    ds_read_b128 a[168:171], v4 offset:43008
    ds_read_b128 a[172:175], v4 offset:44032
    ds_read_b128 a[176:179], v4 offset:45056
    ds_read_b128 a[180:183], v4 offset:46080
    ds_read_b128 a[184:187], v4 offset:47104
    ds_read_b128 a[188:191], v4 offset:48128
    ds_read_b128 a[192:195], v4 offset:49152
    ds_read_b128 a[196:199], v4 offset:50176
    ds_read_b128 a[200:203], v4 offset:51200
    ds_read_b128 a[204:207], v4 offset:52224
    ds_read_b128 a[208:211], v4 offset:53248
    ds_read_b128 a[212:215], v4 offset:54272
    ds_read_b128 a[216:219], v4 offset:55296
    ds_read_b128 a[220:223], v4 offset:56320
    s_lshl_b32 s41, s28, 4
    s_add_u32 s41, s41, s34
    s_mul_i32 s41, s41, 14
    s_add_u32 s41, s41, s35
    s_lshl_b32 s41, s41, 11
    s_add_u32 s47, s41, 12845056
    s_add_u32 s48, s41, 42205184
    s_lshl_b32 s41, s28, 2
    v_mov_b32 v7, s41
    s_mov_b32 s33, 0
    s_waitcnt vmcnt(2) lgkmcnt(0)
H_gemm:
    s_add_u32 s45, s45, 114688
    s_cmp_eq_u32 s33, 15
    s_cselect_b32 s45, 75382784, s45
    v_mov_b32 v8, s33
    s_waitcnt vmcnt(30)
    v_mfma_f32_16x16x32_bf16 v[144:147], v[32:35], a[0:3], 0
    v_mfma_f32_16x16x32_bf16 v[148:151], v[32:35], a[56:59], 0
    v_mfma_f32_16x16x32_bf16 v[160:163], a[112:115], v[32:35], 0
    v_mfma_f32_16x16x32_bf16 v[164:167], a[168:171], v[32:35], 0
    s_add_u32 s43, s45, 0
    buffer_load_dwordx4 v[32:35], v4, s[16:19], s43 offen offset:0 sc1
    v_mfma_f32_16x16x32_bf16 v[152:155], v[36:39], a[0:3], 0
    v_mfma_f32_16x16x32_bf16 v[156:159], v[36:39], a[56:59], 0
    v_mfma_f32_16x16x32_bf16 v[168:171], a[112:115], v[36:39], 0
    v_mfma_f32_16x16x32_bf16 v[172:175], a[168:171], v[36:39], 0
    s_add_u32 s43, s45, 12288
    buffer_load_dwordx4 v[36:39], v4, s[16:19], s43 offen offset:2048 sc1
    s_waitcnt vmcnt(30)
    v_mfma_f32_16x16x32_bf16 v[144:147], v[40:43], a[4:7], v[144:147]
    v_mfma_f32_16x16x32_bf16 v[148:151], v[40:43], a[60:63], v[148:151]
    v_mfma_f32_16x16x32_bf16 v[160:163], a[116:119], v[40:43], v[160:163]
    v_mfma_f32_16x16x32_bf16 v[164:167], a[172:175], v[40:43], v[164:167]
    s_add_u32 s43, s45, 0
    buffer_load_dwordx4 v[40:43], v4, s[16:19], s43 offen offset:1024 sc1
    v_mfma_f32_16x16x32_bf16 v[152:155], v[44:47], a[4:7], v[152:155]
    v_mfma_f32_16x16x32_bf16 v[156:159], v[44:47], a[60:63], v[156:159]
    v_mfma_f32_16x16x32_bf16 v[168:171], a[116:119], v[44:47], v[168:171]
    v_mfma_f32_16x16x32_bf16 v[172:175], a[172:175], v[44:47], v[172:175]
    s_add_u32 s43, s45, 12288
    buffer_load_dwordx4 v[44:47], v4, s[16:19], s43 offen offset:3072 sc1
    s_waitcnt vmcnt(30)
    v_mfma_f32_16x16x32_bf16 v[144:147], v[48:51], a[8:11], v[144:147]
    v_mfma_f32_16x16x32_bf16 v[148:151], v[48:51], a[64:67], v[148:151]
    v_mfma_f32_16x16x32_bf16 v[160:163], a[120:123], v[48:51], v[160:163]
    v_mfma_f32_16x16x32_bf16 v[164:167], a[176:179], v[48:51], v[164:167]
    s_add_u32 s43, s45, 0
    buffer_load_dwordx4 v[48:51], v4, s[16:19], s43 offen offset:2048 sc1
    v_mfma_f32_16x16x32_bf16 v[152:155], v[52:55], a[8:11], v[152:155]
    v_mfma_f32_16x16x32_bf16 v[156:159], v[52:55], a[64:67], v[156:159]
    v_mfma_f32_16x16x32_bf16 v[168:171], a[120:123], v[52:55], v[168:171]
    v_mfma_f32_16x16x32_bf16 v[172:175], a[176:179], v[52:55], v[172:175]
    s_add_u32 s43, s45, 16384
    buffer_load_dwordx4 v[52:55], v4, s[16:19], s43 offen offset:0 sc1
    s_waitcnt vmcnt(6)
    s_mov_b64 exec, 1
    buffer_store_dword v8, v7, s[16:19], s37 offen sc1
    s_mov_b64 exec, -1
    v_mfma_f32_16x16x32_bf16 v[144:147], v[56:59], a[12:15], v[144:147]
    v_mfma_f32_16x16x32_bf16 v[148:151], v[56:59], a[68:71], v[148:151]
    v_mfma_f32_16x16x32_bf16 v[160:163], a[124:127], v[56:59], v[160:163]
    v_mfma_f32_16x16x32_bf16 v[164:167], a[180:183], v[56:59], v[164:167]
    s_add_u32 s43, s45, 0
    buffer_load_dwordx4 v[56:59], v4, s[16:19], s43 offen offset:3072 sc1
    v_mfma_f32_16x16x32_bf16 v[152:155], v[60:63], a[12:15], v[152:155]
    v_mfma_f32_16x16x32_bf16 v[156:159], v[60:63], a[68:71], v[156:159]
    v_mfma_f32_16x16x32_bf16 v[168:171], a[124:127], v[60:63], v[168:171]
    v_mfma_f32_16x16x32_bf16 v[172:175], a[180:183], v[60:63], v[172:175]
    s_add_u32 s43, s45, 16384
    buffer_load_dwordx4 v[60:63], v4, s[16:19], s43 offen offset:1024 sc1
    s_waitcnt vmcnt(9)
    v_mfma_f32_16x16x32_bf16 v[144:147], v[64:67], a[16:19], v[144:147]
    v_mfma_f32_16x16x32_bf16 v[148:151], v[64:67], a[72:75], v[148:151]
    v_mfma_f32_16x16x32_bf16 v[160:163], a[128:131], v[64:67], v[160:163]
    v_mfma_f32_16x16x32_bf16 v[164:167], a[184:187], v[64:67], v[164:167]
    s_add_u32 s43, s45, 4096
    buffer_load_dwordx4 v[64:67], v4, s[16:19], s43 offen offset:0 sc1
    v_mfma_f32_16x16x32_bf16 v[152:155], v[68:71], a[16:19], v[152:155]
    v_mfma_f32_16x16x32_bf16 v[156:159], v[68:71], a[72:75], v[156:159]
    v_mfma_f32_16x16x32_bf16 v[168:171], a[128:131], v[68:71], v[168:171]
    v_mfma_f32_16x16x32_bf16 v[172:175], a[184:187], v[68:71], v[172:175]
    s_add_u32 s43, s45, 16384
    buffer_load_dwordx4 v[68:71], v4, s[16:19], s43 offen offset:2048 sc1
    s_waitcnt vmcnt(11)
    v_mfma_f32_16x16x32_bf16 v[144:147], v[72:75], a[20:23], v[144:147]
    v_mfma_f32_16x16x32_bf16 v[148:151], v[72:75], a[76:79], v[148:151]
    v_mfma_f32_16x16x32_bf16 v[160:163], a[132:135], v[72:75], v[160:163]
    v_mfma_f32_16x16x32_bf16 v[164:167], a[188:191], v[72:75], v[164:167]
    s_add_u32 s43, s45, 4096
    buffer_load_dwordx4 v[72:75], v4, s[16:19], s43 offen offset:1024 sc1
    v_mfma_f32_16x16x32_bf16 v[152:155], v[76:79], a[20:23], v[152:155]
    v_mfma_f32_16x16x32_bf16 v[156:159], v[76:79], a[76:79], v[156:159]
    v_mfma_f32_16x16x32_bf16 v[168:171], a[132:135], v[76:79], v[168:171]
    v_mfma_f32_16x16x32_bf16 v[172:175], a[188:191], v[76:79], v[172:175]
    s_add_u32 s43, s45, 16384
    buffer_load_dwordx4 v[76:79], v4, s[16:19], s43 offen offset:3072 sc1
    s_waitcnt vmcnt(13)
    v_mfma_f32_16x16x32_bf16 v[144:147], v[80:83], a[24:27], v[144:147]
    v_mfma_f32_16x16x32_bf16 v[148:151], v[80:83], a[80:83], v[148:151]
    v_mfma_f32_16x16x32_bf16 v[160:163], a[136:139], v[80:83], v[160:163]
    v_mfma_f32_16x16x32_bf16 v[164:167], a[192:195], v[80:83], v[164:167]
    s_add_u32 s43, s45, 4096
    buffer_load_dwordx4 v[80:83], v4, s[16:19], s43 offen offset:2048 sc1
    v_mfma_f32_16x16x32_bf16 v[152:155], v[84:87], a[24:27], v[152:155]
    v_mfma_f32_16x16x32_bf16 v[156:159], v[84:87], a[80:83], v[156:159]
    v_mfma_f32_16x16x32_bf16 v[168:171], a[136:139], v[84:87], v[168:171]
    v_mfma_f32_16x16x32_bf16 v[172:175], a[192:195], v[84:87], v[172:175]
    s_add_u32 s43, s45, 20480
    buffer_load_dwordx4 v[84:87], v4, s[16:19], s43 offen offset:0 sc1
    s_waitcnt vmcnt(15)
    v_mfma_f32_16x16x32_bf16 v[144:147], v[88:91], a[28:31], v[144:147]
    v_mfma_f32_16x16x32_bf16 v[148:151], v[88:91], a[84:87], v[148:151]
    v_mfma_f32_16x16x32_bf16 v[160:163], a[140:143], v[88:91], v[160:163]
    v_mfma_f32_16x16x32_bf16 v[164:167], a[196:199], v[88:91], v[164:167]
    s_add_u32 s43, s45, 4096
    buffer_load_dwordx4 v[88:91], v4, s[16:19], s43 offen offset:3072 sc1
    v_mfma_f32_16x16x32_bf16 v[152:155], v[92:95], a[28:31], v[152:155]
    v_mfma_f32_16x16x32_bf16 v[156:159], v[92:95], a[84:87], v[156:159]
    v_mfma_f32_16x16x32_bf16 v[168:171], a[140:143], v[92:95], v[168:171]
    v_mfma_f32_16x16x32_bf16 v[172:175], a[196:199], v[92:95], v[172:175]
    s_add_u32 s43, s45, 20480
    buffer_load_dwordx4 v[92:95], v4, s[16:19], s43 offen offset:1024 sc1
    s_waitcnt vmcnt(17)
    v_mfma_f32_16x16x32_bf16 v[144:147], v[96:99], a[32:35], v[144:147]
    v_mfma_f32_16x16x32_bf16 v[148:151], v[96:99], a[88:91], v[148:151]
    v_mfma_f32_16x16x32_bf16 v[160:163], a[144:147], v[96:99], v[160:163]
    v_mfma_f32_16x16x32_bf16 v[164:167], a[200:203], v[96:99], v[164:167]
    s_add_u32 s43, s45, 8192
    buffer_load_dwordx4 v[96:99], v4, s[16:19], s43 offen offset:0 sc1
    v_mfma_f32_16x16x32_bf16 v[152:155], v[100:103], a[32:35], v[152:155]
    v_mfma_f32_16x16x32_bf16 v[156:159], v[100:103], a[88:91], v[156:159]
    v_mfma_f32_16x16x32_bf16 v[168:171], a[144:147], v[100:103], v[168:171]
    v_mfma_f32_16x16x32_bf16 v[172:175], a[200:203], v[100:103], v[172:175]
    s_add_u32 s43, s45, 20480
    buffer_load_dwordx4 v[100:103], v4, s[16:19], s43 offen offset:2048 sc1
    s_waitcnt vmcnt(19)
    v_mfma_f32_16x16x32_bf16 v[144:147], v[104:107], a[36:39], v[144:147]
    v_mfma_f32_16x16x32_bf16 v[148:151], v[104:107], a[92:95], v[148:151]
    v_mfma_f32_16x16x32_bf16 v[160:163], a[148:151], v[104:107], v[160:163]
    v_mfma_f32_16x16x32_bf16 v[164:167], a[204:207], v[104:107], v[164:167]
    s_add_u32 s43, s45, 8192
    buffer_load_dwordx4 v[104:107], v4, s[16:19], s43 offen offset:1024 sc1
    v_mfma_f32_16x16x32_bf16 v[152:155], v[108:111], a[36:39], v[152:155]
    v_mfma_f32_16x16x32_bf16 v[156:159], v[108:111], a[92:95], v[156:159]
    v_mfma_f32_16x16x32_bf16 v[168:171], a[148:151], v[108:111], v[168:171]
    v_mfma_f32_16x16x32_bf16 v[172:175], a[204:207], v[108:111], v[172:175]
    s_add_u32 s43, s45, 20480
    buffer_load_dwordx4 v[108:111], v4, s[16:19], s43 offen offset:3072 sc1
    s_waitcnt vmcnt(21)
    v_mfma_f32_16x16x32_bf16 v[144:147], v[112:115], a[40:43], v[144:147]
    v_mfma_f32_16x16x32_bf16 v[148:151], v[112:115], a[96:99], v[148:151]
    v_mfma_f32_16x16x32_bf16 v[160:163], a[152:155], v[112:115], v[160:163]
    v_mfma_f32_16x16x32_bf16 v[164:167], a[208:211], v[112:115], v[164:167]
    s_add_u32 s43, s45, 8192
    buffer_load_dwordx4 v[112:115], v4, s[16:19], s43 offen offset:2048 sc1
    v_mfma_f32_16x16x32_bf16 v[152:155], v[116:119], a[40:43], v[152:155]
    v_mfma_f32_16x16x32_bf16 v[156:159], v[116:119], a[96:99], v[156:159]
    v_mfma_f32_16x16x32_bf16 v[168:171], a[152:155], v[116:119], v[168:171]
    v_mfma_f32_16x16x32_bf16 v[172:175], a[208:211], v[116:119], v[172:175]
    s_add_u32 s43, s45, 24576
    buffer_load_dwordx4 v[116:119], v4, s[16:19], s43 offen offset:0 sc1
    s_waitcnt vmcnt(23)
    v_mfma_f32_16x16x32_bf16 v[144:147], v[120:123], a[44:47], v[144:147]
    v_mfma_f32_16x16x32_bf16 v[148:151], v[120:123], a[100:103], v[148:151]
    v_mfma_f32_16x16x32_bf16 v[160:163], a[156:159], v[120:123], v[160:163]
    v_mfma_f32_16x16x32_bf16 v[164:167], a[212:215], v[120:123], v[164:167]
    s_add_u32 s43, s45, 8192
    buffer_load_dwordx4 v[120:123], v4, s[16:19], s43 offen offset:3072 sc1
    v_mfma_f32_16x16x32_bf16 v[152:155], v[124:127], a[44:47], v[152:155]
    v_mfma_f32_16x16x32_bf16 v[156:159], v[124:127], a[100:103], v[156:159]
    v_mfma_f32_16x16x32_bf16 v[168:171], a[156:159], v[124:127], v[168:171]
    v_mfma_f32_16x16x32_bf16 v[172:175], a[212:215], v[124:127], v[172:175]
    s_add_u32 s43, s45, 24576
    buffer_load_dwordx4 v[124:127], v4, s[16:19], s43 offen offset:1024 sc1
    s_waitcnt vmcnt(25)
    v_mfma_f32_16x16x32_bf16 v[144:147], v[128:131], a[48:51], v[144:147]
    v_mfma_f32_16x16x32_bf16 v[148:151], v[128:131], a[104:107], v[148:151]
    v_mfma_f32_16x16x32_bf16 v[160:163], a[160:163], v[128:131], v[160:163]
    v_mfma_f32_16x16x32_bf16 v[164:167], a[216:219], v[128:131], v[164:167]
    s_add_u32 s43, s45, 12288
    buffer_load_dwordx4 v[128:131], v4, s[16:19], s43 offen offset:0 sc1
    v_mfma_f32_16x16x32_bf16 v[152:155], v[132:135], a[48:51], v[152:155]
    v_mfma_f32_16x16x32_bf16 v[156:159], v[132:135], a[104:107], v[156:159]
    v_mfma_f32_16x16x32_bf16 v[168:171], a[160:163], v[132:135], v[168:171]
    v_mfma_f32_16x16x32_bf16 v[172:175], a[216:219], v[132:135], v[172:175]
    s_add_u32 s43, s45, 24576
    buffer_load_dwordx4 v[132:135], v4, s[16:19], s43 offen offset:2048 sc1
    s_waitcnt vmcnt(27)
    v_mfma_f32_16x16x32_bf16 v[144:147], v[136:139], a[52:55], v[144:147]
    v_mfma_f32_16x16x32_bf16 v[148:151], v[136:139], a[108:111], v[148:151]
    v_mfma_f32_16x16x32_bf16 v[160:163], a[164:167], v[136:139], v[160:163]
    v_mfma_f32_16x16x32_bf16 v[164:167], a[220:223], v[136:139], v[164:167]
    s_add_u32 s43, s45, 12288
    buffer_load_dwordx4 v[136:139], v4, s[16:19], s43 offen offset:1024 sc1
    v_mfma_f32_16x16x32_bf16 v[152:155], v[140:143], a[52:55], v[152:155]
    v_mfma_f32_16x16x32_bf16 v[156:159], v[140:143], a[108:111], v[156:159]
    v_mfma_f32_16x16x32_bf16 v[168:171], a[164:167], v[140:143], v[168:171]
    v_mfma_f32_16x16x32_bf16 v[172:175], a[220:223], v[140:143], v[172:175]
    s_add_u32 s43, s45, 24576
    buffer_load_dwordx4 v[140:143], v4, s[16:19], s43 offen offset:3072 sc1
    v_cvt_pk_bf16_f32 v16, v144, v145
    v_cvt_pk_bf16_f32 v17, v146, v147
    v_cvt_pk_bf16_f32 v18, v152, v153
    v_cvt_pk_bf16_f32 v19, v154, v155
    buffer_store_dwordx4 v[16:19], v4, s[16:19], s47 offen offset:0 sc1
    v_cvt_pk_bf16_f32 v20, v148, v149
    v_cvt_pk_bf16_f32 v21, v150, v151
    v_cvt_pk_bf16_f32 v22, v156, v157
    v_cvt_pk_bf16_f32 v23, v158, v159
    buffer_store_dwordx4 v[20:23], v4, s[16:19], s47 offen offset:1024 sc1
    v_cvt_pk_bf16_f32 v24, v160, v161
    v_cvt_pk_bf16_f32 v25, v162, v163
    v_cvt_pk_bf16_f32 v26, v164, v165
    v_cvt_pk_bf16_f32 v27, v166, v167
    buffer_store_dwordx4 v[24:27], v4, s[16:19], s48 offen offset:0 sc1
    v_cvt_pk_bf16_f32 v28, v168, v169
    v_cvt_pk_bf16_f32 v29, v170, v171
    v_cvt_pk_bf16_f32 v30, v172, v173
    v_cvt_pk_bf16_f32 v31, v174, v175
    buffer_store_dwordx4 v[28:31], v4, s[16:19], s48 offen offset:1024 sc1
    s_add_u32 s47, s47, 1835008
    s_add_u32 s48, s48, 1835008
    s_add_u32 s33, s33, 1
    s_cmp_lg_u32 s33, 99
    s_cbranch_scc1 H_nopause
    v_mov_b32 v8, s33
    v_mov_b32 v9, 95142080
    s_waitcnt vmcnt(0)
    s_mov_b64 exec, 1
    buffer_store_dword v8, v7, s[16:19], s37 offen sc1
    s_mov_b64 exec, -1
    s_mov_b32 s32, 200000
H_pause:
    buffer_load_dword v10, v9, s[16:19], 0 offen sc1
    s_waitcnt vmcnt(0)
    v_cmp_eq_u32 vcc, s59, v10
    s_cbranch_vccnz H_nopause
    s_sleep 16
    s_sub_u32 s32, s32, 1
    s_cmp_lg_u32 s32, 0
    s_cbranch_scc1 H_pause
H_nopause:
    s_cmp_lt_u32 s33, 16
    s_cbranch_scc1 H_gemm
    v_mov_b32 v8, 16
    s_waitcnt vmcnt(0)
    s_mov_b64 exec, 1
    buffer_store_dword v8, v7, s[16:19], s37 offen sc1
    s_mov_b64 exec, -1
    s_cmp_lt_u32 s36, 28
    s_cbranch_scc0 H_phase2
    s_load_dwordx4 s[64:67], s[0:1], 72
    s_load_dwordx2 s[68:69], s[0:1], 88
    s_mov_b32 s41, 77217792
    s_mov_b32 s42, 77221888
    buffer_load_dwordx4 v[32:35], v4, s[16:19], s41 offen offset:0 sc1
    buffer_load_dwordx4 v[36:39], v4, s[16:19], s41 offen offset:1024 sc1
    buffer_load_dwordx4 v[40:43], v4, s[16:19], s41 offen offset:2048 sc1
    buffer_load_dwordx4 v[44:47], v4, s[16:19], s41 offen offset:3072 sc1
    buffer_load_dwordx4 v[48:51], v4, s[16:19], s42 offen offset:0 sc1
    buffer_load_dwordx4 v[52:55], v4, s[16:19], s42 offen offset:1024 sc1
    buffer_load_dwordx4 v[56:59], v4, s[16:19], s42 offen offset:2048 sc1
    buffer_load_dwordx4 v[60:63], v4, s[16:19], s42 offen offset:3072 sc1
    s_waitcnt lgkmcnt(0)
    s_mov_b32 s48, s64
    s_mov_b32 s49, s65
    s_mov_b32 s50, 1605632
    s_mov_b32 s51, 0x20000
    s_mov_b32 s52, s66
    s_mov_b32 s53, s67
    s_mov_b32 s54, 1605632
    s_mov_b32 s55, 0x20000
    s_mov_b32 s56, s68
    s_mov_b32 s57, s69
    s_mov_b32 s58, 1605632
    s_mov_b32 s59, 0x20000
    s_waitcnt vmcnt(0)
    v_max3_f32 v8, v32, v33, v34
    v_max3_f32 v8, v8, v35, v36
    v_max3_f32 v8, v8, v37, v38
    v_max3_f32 v8, v8, v39, v40
    v_max3_f32 v8, v8, v41, v42
    v_max3_f32 v8, v8, v43, v44
    v_max3_f32 v8, v8, v45, v46
    v_max3_f32 v8, v8, v47, v48
    v_max3_f32 v8, v8, v49, v50
    v_max3_f32 v8, v8, v51, v52
    v_max3_f32 v8, v8, v53, v54
    v_max3_f32 v8, v8, v55, v56
    v_max3_f32 v8, v8, v57, v58
    v_max3_f32 v8, v8, v59, v60
    v_max3_f32 v8, v8, v61, v62
    v_max_f32 v8, v8, v63
    s_nop 1
    v_max_f32_dpp v8, v8, v8 quad_perm:[1,0,3,2] row_mask:0xf bank_mask:0xf
    s_nop 1
    v_max_f32_dpp v8, v8, v8 quad_perm:[2,3,0,1] row_mask:0xf bank_mask:0xf
    s_nop 1
    v_max_f32_dpp v8, v8, v8 row_half_mirror row_mask:0xf bank_mask:0xf
    s_nop 1
    v_max_f32_dpp v8, v8, v8 row_mirror row_mask:0xf bank_mask:0xf
    v_mov_b32 v9, v8
    s_nop 1
    v_permlane16_swap_b32 v8, v9
    v_max_f32 v8, v8, v9
    v_mov_b32 v9, v8
    s_nop 1
    v_permlane32_swap_b32 v8, v9
    v_max_f32 v8, v8, v9
    v_lshlrev_b32 v10, 2, v1
    v_mov_b32 v11, 0x7fffffff
    v_cmp_eq_f32 vcc, v8, v63
    v_add_u32 v12, 1795, v10
    s_nop 0
    v_cndmask_b32 v11, v11, v12, vcc
    v_cmp_eq_f32 vcc, v8, v62
    v_add_u32 v12, 1794, v10
    s_nop 0
    v_cndmask_b32 v11, v11, v12, vcc
    v_cmp_eq_f32 vcc, v8, v61
    v_add_u32 v12, 1793, v10
    s_nop 0
    v_cndmask_b32 v11, v11, v12, vcc
    v_cmp_eq_f32 vcc, v8, v60
    v_add_u32 v12, 1792, v10
    s_nop 0
    v_cndmask_b32 v11, v11, v12, vcc
    v_cmp_eq_f32 vcc, v8, v59
    v_add_u32 v12, 1539, v10
    s_nop 0
    v_cndmask_b32 v11, v11, v12, vcc
    v_cmp_eq_f32 vcc, v8, v58
    v_add_u32 v12, 1538, v10
    s_nop 0
    v_cndmask_b32 v11, v11, v12, vcc
    v_cmp_eq_f32 vcc, v8, v57
    v_add_u32 v12, 1537, v10
    s_nop 0
    v_cndmask_b32 v11, v11, v12, vcc
    v_cmp_eq_f32 vcc, v8, v56
    v_add_u32 v12, 1536, v10
    s_nop 0
    v_cndmask_b32 v11, v11, v12, vcc
    v_cmp_eq_f32 vcc, v8, v55
    v_add_u32 v12, 1283, v10
    s_nop 0
    v_cndmask_b32 v11, v11, v12, vcc
    v_cmp_eq_f32 vcc, v8, v54
    v_add_u32 v12, 1282, v10
    s_nop 0
    v_cndmask_b32 v11, v11, v12, vcc
    v_cmp_eq_f32 vcc, v8, v53
    v_add_u32 v12, 1281, v10
    s_nop 0
    v_cndmask_b32 v11, v11, v12, vcc
    v_cmp_eq_f32 vcc, v8, v52
    v_add_u32 v12, 1280, v10
    s_nop 0
    v_cndmask_b32 v11, v11, v12, vcc
    v_cmp_eq_f32 vcc, v8, v51
    v_add_u32 v12, 1027, v10
    s_nop 0
    v_cndmask_b32 v11, v11, v12, vcc
    v_cmp_eq_f32 vcc, v8, v50
    v_add_u32 v12, 1026, v10
    s_nop 0
    v_cndmask_b32 v11, v11, v12, vcc
    v_cmp_eq_f32 vcc, v8, v49
    v_add_u32 v12, 1025, v10
    s_nop 0
    v_cndmask_b32 v11, v11, v12, vcc
    v_cmp_eq_f32 vcc, v8, v48
    v_add_u32 v12, 1024, v10
    s_nop 0
    v_cndmask_b32 v11, v11, v12, vcc
    v_cmp_eq_f32 vcc, v8, v47
    v_add_u32 v12, 771, v10
    s_nop 0
    v_cndmask_b32 v11, v11, v12, vcc
    v_cmp_eq_f32 vcc, v8, v46
    v_add_u32 v12, 770, v10
    s_nop 0
    v_cndmask_b32 v11, v11, v12, vcc
    v_cmp_eq_f32 vcc, v8, v45
    v_add_u32 v12, 769, v10
    s_nop 0
    v_cndmask_b32 v11, v11, v12, vcc
    v_cmp_eq_f32 vcc, v8, v44
    v_add_u32 v12, 768, v10
    s_nop 0
    v_cndmask_b32 v11, v11, v12, vcc
    v_cmp_eq_f32 vcc, v8, v43
    v_add_u32 v12, 515, v10
    s_nop 0
    v_cndmask_b32 v11, v11, v12, vcc
    v_cmp_eq_f32 vcc, v8, v42
    v_add_u32 v12, 514, v10
    s_nop 0
    v_cndmask_b32 v11, v11, v12, vcc
    v_cmp_eq_f32 vcc, v8, v41
    v_add_u32 v12, 513, v10
    s_nop 0
    v_cndmask_b32 v11, v11, v12, vcc
    v_cmp_eq_f32 vcc, v8, v40
    v_add_u32 v12, 512, v10
    s_nop 0
    v_cndmask_b32 v11, v11, v12, vcc
    v_cmp_eq_f32 vcc, v8, v39
    v_add_u32 v12, 259, v10
    s_nop 0
    v_cndmask_b32 v11, v11, v12, vcc
    v_cmp_eq_f32 vcc, v8, v38
    v_add_u32 v12, 258, v10
    s_nop 0
    v_cndmask_b32 v11, v11, v12, vcc
    v_cmp_eq_f32 vcc, v8, v37
    v_add_u32 v12, 257, v10
    s_nop 0
    v_cndmask_b32 v11, v11, v12, vcc
    v_cmp_eq_f32 vcc, v8, v36
    v_add_u32 v12, 256, v10
    s_nop 0
    v_cndmask_b32 v11, v11, v12, vcc
    v_cmp_eq_f32 vcc, v8, v35
    v_add_u32 v12, 3, v10
    s_nop 0
    v_cndmask_b32 v11, v11, v12, vcc
    v_cmp_eq_f32 vcc, v8, v34
    v_add_u32 v12, 2, v10
    s_nop 0
    v_cndmask_b32 v11, v11, v12, vcc
    v_cmp_eq_f32 vcc, v8, v33
    v_add_u32 v12, 1, v10
    s_nop 0
    v_cndmask_b32 v11, v11, v12, vcc
    v_cmp_eq_f32 vcc, v8, v32
    v_add_u32 v12, 0, v10
    s_nop 0
    v_cndmask_b32 v11, v11, v12, vcc
    s_nop 1
    v_min_u32_dpp v11, v11, v11 quad_perm:[1,0,3,2] row_mask:0xf bank_mask:0xf
    s_nop 1
    v_min_u32_dpp v11, v11, v11 quad_perm:[2,3,0,1] row_mask:0xf bank_mask:0xf
    s_nop 1
    v_min_u32_dpp v11, v11, v11 row_half_mirror row_mask:0xf bank_mask:0xf
    s_nop 1
    v_min_u32_dpp v11, v11, v11 row_mirror row_mask:0xf bank_mask:0xf
    v_mov_b32 v9, v11
    s_nop 1
    v_permlane16_swap_b32 v11, v9
    v_min_u32 v11, v11, v9
    v_mov_b32 v9, v11
    s_nop 1
    v_permlane32_swap_b32 v11, v9
    v_min_u32 v11, v11, v9
    v_min_u32 v11, 2047, v11
    s_nop 0
    v_readfirstlane_b32 s60, v11
    v_readfirstlane_b32 s61, v8
    v_lshrrev_b32 v12, 3, v1
    v_and_b32 v13, 7, v1
    v_lshlrev_b32 v14, 1, v12
    v_mul_u32_u24 v15, 3584, v12
    v_lshl_add_u32 v15, v13, 4, v15
    s_mul_i32 s41, s60, 896
    s_mul_i32 s42, s28, 224
    s_add_u32 s41, s41, s42
    s_mul_i32 s42, s28, 401408
    s_lshl_b32 s43, s36, 7
    s_add_u32 s42, s42, s43
    buffer_load_ushort v16, v14, s[20:23], s41 offen offset:0
    buffer_load_ushort v17, v14, s[20:23], s41 offen offset:16
    buffer_load_ushort v18, v14, s[20:23], s41 offen offset:32
    buffer_load_ushort v19, v14, s[20:23], s41 offen offset:48
    buffer_load_ushort v20, v14, s[20:23], s41 offen offset:64
    buffer_load_ushort v21, v14, s[20:23], s41 offen offset:80
    buffer_load_ushort v22, v14, s[20:23], s41 offen offset:96
    buffer_load_ushort v23, v14, s[20:23], s41 offen offset:112
    buffer_load_ushort v24, v14, s[20:23], s41 offen offset:128
    buffer_load_ushort v25, v14, s[20:23], s41 offen offset:144
    buffer_load_ushort v26, v14, s[20:23], s41 offen offset:160
    buffer_load_ushort v27, v14, s[20:23], s41 offen offset:176
    buffer_load_ushort v28, v14, s[20:23], s41 offen offset:192
    buffer_load_ushort v29, v14, s[20:23], s41 offen offset:208
    buffer_load_dwordx4 v[32:35], v15, s[48:51], s42 offen
    buffer_load_dwordx4 v[88:91], v15, s[52:55], s42 offen
    s_add_u32 s42, s42, 28672
    buffer_load_dwordx4 v[36:39], v15, s[48:51], s42 offen
    buffer_load_dwordx4 v[92:95], v15, s[52:55], s42 offen
    s_add_u32 s42, s42, 28672
    buffer_load_dwordx4 v[40:43], v15, s[48:51], s42 offen
    buffer_load_dwordx4 v[96:99], v15, s[52:55], s42 offen
    s_add_u32 s42, s42, 28672
    buffer_load_dwordx4 v[44:47], v15, s[48:51], s42 offen
    buffer_load_dwordx4 v[100:103], v15, s[52:55], s42 offen
    s_add_u32 s42, s42, 28672
    buffer_load_dwordx4 v[48:51], v15, s[48:51], s42 offen
    buffer_load_dwordx4 v[104:107], v15, s[52:55], s42 offen
    s_add_u32 s42, s42, 28672
    buffer_load_dwordx4 v[52:55], v15, s[48:51], s42 offen
    buffer_load_dwordx4 v[108:111], v15, s[52:55], s42 offen
    s_add_u32 s42, s42, 28672
    buffer_load_dwordx4 v[56:59], v15, s[48:51], s42 offen
    buffer_load_dwordx4 v[112:115], v15, s[52:55], s42 offen
    s_add_u32 s42, s42, 28672
    buffer_load_dwordx4 v[60:63], v15, s[48:51], s42 offen
    buffer_load_dwordx4 v[116:119], v15, s[52:55], s42 offen
    s_add_u32 s42, s42, 28672
    buffer_load_dwordx4 v[64:67], v15, s[48:51], s42 offen
    buffer_load_dwordx4 v[120:123], v15, s[52:55], s42 offen
    s_add_u32 s42, s42, 28672
    buffer_load_dwordx4 v[68:71], v15, s[48:51], s42 offen
    buffer_load_dwordx4 v[124:127], v15, s[52:55], s42 offen
    s_add_u32 s42, s42, 28672
    buffer_load_dwordx4 v[72:75], v15, s[48:51], s42 offen
    buffer_load_dwordx4 v[128:131], v15, s[52:55], s42 offen
    s_add_u32 s42, s42, 28672
    buffer_load_dwordx4 v[76:79], v15, s[48:51], s42 offen
    buffer_load_dwordx4 v[132:135], v15, s[52:55], s42 offen
    s_add_u32 s42, s42, 28672
    buffer_load_dwordx4 v[80:83], v15, s[48:51], s42 offen
    buffer_load_dwordx4 v[136:139], v15, s[52:55], s42 offen
    s_add_u32 s42, s42, 28672
    buffer_load_dwordx4 v[84:87], v15, s[48:51], s42 offen
    buffer_load_dwordx4 v[140:143], v15, s[52:55], s42 offen
    s_add_u32 s42, s42, 28672
    v_mov_b32 v144, 0
    v_mov_b32 v145, 0
    v_mov_b32 v146, 0
    v_mov_b32 v147, 0
    v_mov_b32 v148, 0
    v_mov_b32 v149, 0
    v_mov_b32 v150, 0
    v_mov_b32 v151, 0
    v_mov_b32 v152, 0
    v_mov_b32 v153, 0
    v_mov_b32 v154, 0
    v_mov_b32 v155, 0
    v_mov_b32 v156, 0
    v_mov_b32 v157, 0
    v_mov_b32 v158, 0
    v_mov_b32 v159, 0
    s_waitcnt vmcnt(26)
    v_lshlrev_b32 v16, 16, v16
    v_lshlrev_b32 v8, 16, v32
    v_and_b32 v9, 0xffff0000, v32
    v_fmac_f32 v144, v8, v16
    v_fmac_f32 v145, v9, v16
    v_lshlrev_b32 v8, 16, v33
    v_and_b32 v9, 0xffff0000, v33
    v_fmac_f32 v146, v8, v16
    v_fmac_f32 v147, v9, v16
    v_lshlrev_b32 v8, 16, v34
    v_and_b32 v9, 0xffff0000, v34
    v_fmac_f32 v148, v8, v16
    v_fmac_f32 v149, v9, v16
    v_lshlrev_b32 v8, 16, v35
    v_and_b32 v9, 0xffff0000, v35
    v_fmac_f32 v150, v8, v16
    v_fmac_f32 v151, v9, v16
    v_lshlrev_b32 v8, 16, v88
    v_and_b32 v9, 0xffff0000, v88
    v_fmac_f32 v152, v8, v16
    v_fmac_f32 v153, v9, v16
    v_lshlrev_b32 v8, 16, v89
    v_and_b32 v9, 0xffff0000, v89
    v_fmac_f32 v154, v8, v16
    v_fmac_f32 v155, v9, v16
    v_lshlrev_b32 v8, 16, v90
    v_and_b32 v9, 0xffff0000, v90
    v_fmac_f32 v156, v8, v16
    v_fmac_f32 v157, v9, v16
    v_lshlrev_b32 v8, 16, v91
    v_and_b32 v9, 0xffff0000, v91
    v_fmac_f32 v158, v8, v16
    v_fmac_f32 v159, v9, v16
    s_waitcnt vmcnt(24)
    v_lshlrev_b32 v17, 16, v17
    v_lshlrev_b32 v8, 16, v36
    v_and_b32 v9, 0xffff0000, v36
    v_fmac_f32 v144, v8, v17
    v_fmac_f32 v145, v9, v17
    v_lshlrev_b32 v8, 16, v37
    v_and_b32 v9, 0xffff0000, v37
    v_fmac_f32 v146, v8, v17
    v_fmac_f32 v147, v9, v17
    v_lshlrev_b32 v8, 16, v38
    v_and_b32 v9, 0xffff0000, v38
    v_fmac_f32 v148, v8, v17
    v_fmac_f32 v149, v9, v17
    v_lshlrev_b32 v8, 16, v39
    v_and_b32 v9, 0xffff0000, v39
    v_fmac_f32 v150, v8, v17
    v_fmac_f32 v151, v9, v17
    v_lshlrev_b32 v8, 16, v92
    v_and_b32 v9, 0xffff0000, v92
    v_fmac_f32 v152, v8, v17
    v_fmac_f32 v153, v9, v17
    v_lshlrev_b32 v8, 16, v93
    v_and_b32 v9, 0xffff0000, v93
    v_fmac_f32 v154, v8, v17
    v_fmac_f32 v155, v9, v17
    v_lshlrev_b32 v8, 16, v94
    v_and_b32 v9, 0xffff0000, v94
    v_fmac_f32 v156, v8, v17
    v_fmac_f32 v157, v9, v17
    v_lshlrev_b32 v8, 16, v95
    v_and_b32 v9, 0xffff0000, v95
    v_fmac_f32 v158, v8, v17
    v_fmac_f32 v159, v9, v17
    s_waitcnt vmcnt(22)
    v_lshlrev_b32 v18, 16, v18
    v_lshlrev_b32 v8, 16, v40
    v_and_b32 v9, 0xffff0000, v40
    v_fmac_f32 v144, v8, v18
    v_fmac_f32 v145, v9, v18
    v_lshlrev_b32 v8, 16, v41
    v_and_b32 v9, 0xffff0000, v41
    v_fmac_f32 v146, v8, v18
    v_fmac_f32 v147, v9, v18
    v_lshlrev_b32 v8, 16, v42
    v_and_b32 v9, 0xffff0000, v42
    v_fmac_f32 v148, v8, v18
    v_fmac_f32 v149, v9, v18
    v_lshlrev_b32 v8, 16, v43
    v_and_b32 v9, 0xffff0000, v43
    v_fmac_f32 v150, v8, v18
    v_fmac_f32 v151, v9, v18
    v_lshlrev_b32 v8, 16, v96
    v_and_b32 v9, 0xffff0000, v96
    v_fmac_f32 v152, v8, v18
    v_fmac_f32 v153, v9, v18
    v_lshlrev_b32 v8, 16, v97
    v_and_b32 v9, 0xffff0000, v97
    v_fmac_f32 v154, v8, v18
    v_fmac_f32 v155, v9, v18
    v_lshlrev_b32 v8, 16, v98
    v_and_b32 v9, 0xffff0000, v98
    v_fmac_f32 v156, v8, v18
    v_fmac_f32 v157, v9, v18
    v_lshlrev_b32 v8, 16, v99
    v_and_b32 v9, 0xffff0000, v99
    v_fmac_f32 v158, v8, v18
    v_fmac_f32 v159, v9, v18
    s_waitcnt vmcnt(20)
    v_lshlrev_b32 v19, 16, v19
    v_lshlrev_b32 v8, 16, v44
    v_and_b32 v9, 0xffff0000, v44
    v_fmac_f32 v144, v8, v19
    v_fmac_f32 v145, v9, v19
    v_lshlrev_b32 v8, 16, v45
    v_and_b32 v9, 0xffff0000, v45
    v_fmac_f32 v146, v8, v19
    v_fmac_f32 v147, v9, v19
    v_lshlrev_b32 v8, 16, v46
    v_and_b32 v9, 0xffff0000, v46
    v_fmac_f32 v148, v8, v19
    v_fmac_f32 v149, v9, v19
    v_lshlrev_b32 v8, 16, v47
    v_and_b32 v9, 0xffff0000, v47
    v_fmac_f32 v150, v8, v19
    v_fmac_f32 v151, v9, v19
    v_lshlrev_b32 v8, 16, v100
    v_and_b32 v9, 0xffff0000, v100
    v_fmac_f32 v152, v8, v19
    v_fmac_f32 v153, v9, v19
    v_lshlrev_b32 v8, 16, v101
    v_and_b32 v9, 0xffff0000, v101
    v_fmac_f32 v154, v8, v19
    v_fmac_f32 v155, v9, v19
    v_lshlrev_b32 v8, 16, v102
    v_and_b32 v9, 0xffff0000, v102
    v_fmac_f32 v156, v8, v19
    v_fmac_f32 v157, v9, v19
    v_lshlrev_b32 v8, 16, v103
    v_and_b32 v9, 0xffff0000, v103
    v_fmac_f32 v158, v8, v19
    v_fmac_f32 v159, v9, v19
    s_waitcnt vmcnt(18)
    v_lshlrev_b32 v20, 16, v20
    v_lshlrev_b32 v8, 16, v48
    v_and_b32 v9, 0xffff0000, v48
    v_fmac_f32 v144, v8, v20
    v_fmac_f32 v145, v9, v20
    v_lshlrev_b32 v8, 16, v49
    v_and_b32 v9, 0xffff0000, v49
    v_fmac_f32 v146, v8, v20
    v_fmac_f32 v147, v9, v20
    v_lshlrev_b32 v8, 16, v50
    v_and_b32 v9, 0xffff0000, v50
    v_fmac_f32 v148, v8, v20
    v_fmac_f32 v149, v9, v20
    v_lshlrev_b32 v8, 16, v51
    v_and_b32 v9, 0xffff0000, v51
    v_fmac_f32 v150, v8, v20
    v_fmac_f32 v151, v9, v20
    v_lshlrev_b32 v8, 16, v104
    v_and_b32 v9, 0xffff0000, v104
    v_fmac_f32 v152, v8, v20
    v_fmac_f32 v153, v9, v20
    v_lshlrev_b32 v8, 16, v105
    v_and_b32 v9, 0xffff0000, v105
    v_fmac_f32 v154, v8, v20
    v_fmac_f32 v155, v9, v20
    v_lshlrev_b32 v8, 16, v106
    v_and_b32 v9, 0xffff0000, v106
    v_fmac_f32 v156, v8, v20
    v_fmac_f32 v157, v9, v20
    v_lshlrev_b32 v8, 16, v107
    v_and_b32 v9, 0xffff0000, v107
    v_fmac_f32 v158, v8, v20
    v_fmac_f32 v159, v9, v20
    s_waitcnt vmcnt(16)
    v_lshlrev_b32 v21, 16, v21
    v_lshlrev_b32 v8, 16, v52
    v_and_b32 v9, 0xffff0000, v52
    v_fmac_f32 v144, v8, v21
    v_fmac_f32 v145, v9, v21
    v_lshlrev_b32 v8, 16, v53
    v_and_b32 v9, 0xffff0000, v53
    v_fmac_f32 v146, v8, v21
    v_fmac_f32 v147, v9, v21
    v_lshlrev_b32 v8, 16, v54
    v_and_b32 v9, 0xffff0000, v54
    v_fmac_f32 v148, v8, v21
    v_fmac_f32 v149, v9, v21
    v_lshlrev_b32 v8, 16, v55
    v_and_b32 v9, 0xffff0000, v55
    v_fmac_f32 v150, v8, v21
    v_fmac_f32 v151, v9, v21
    v_lshlrev_b32 v8, 16, v108
    v_and_b32 v9, 0xffff0000, v108
    v_fmac_f32 v152, v8, v21
    v_fmac_f32 v153, v9, v21
    v_lshlrev_b32 v8, 16, v109
    v_and_b32 v9, 0xffff0000, v109
    v_fmac_f32 v154, v8, v21
    v_fmac_f32 v155, v9, v21
    v_lshlrev_b32 v8, 16, v110
    v_and_b32 v9, 0xffff0000, v110
    v_fmac_f32 v156, v8, v21
    v_fmac_f32 v157, v9, v21
    v_lshlrev_b32 v8, 16, v111
    v_and_b32 v9, 0xffff0000, v111
    v_fmac_f32 v158, v8, v21
    v_fmac_f32 v159, v9, v21
    s_waitcnt vmcnt(14)
    v_lshlrev_b32 v22, 16, v22
    v_lshlrev_b32 v8, 16, v56
    v_and_b32 v9, 0xffff0000, v56
    v_fmac_f32 v144, v8, v22
    v_fmac_f32 v145, v9, v22
    v_lshlrev_b32 v8, 16, v57
    v_and_b32 v9, 0xffff0000, v57
    v_fmac_f32 v146, v8, v22
    v_fmac_f32 v147, v9, v22
    v_lshlrev_b32 v8, 16, v58
    v_and_b32 v9, 0xffff0000, v58
    v_fmac_f32 v148, v8, v22
    v_fmac_f32 v149, v9, v22
    v_lshlrev_b32 v8, 16, v59
    v_and_b32 v9, 0xffff0000, v59
    v_fmac_f32 v150, v8, v22
    v_fmac_f32 v151, v9, v22
    v_lshlrev_b32 v8, 16, v112
    v_and_b32 v9, 0xffff0000, v112
    v_fmac_f32 v152, v8, v22
    v_fmac_f32 v153, v9, v22
    v_lshlrev_b32 v8, 16, v113
    v_and_b32 v9, 0xffff0000, v113
    v_fmac_f32 v154, v8, v22
    v_fmac_f32 v155, v9, v22
    v_lshlrev_b32 v8, 16, v114
    v_and_b32 v9, 0xffff0000, v114
    v_fmac_f32 v156, v8, v22
    v_fmac_f32 v157, v9, v22
    v_lshlrev_b32 v8, 16, v115
    v_and_b32 v9, 0xffff0000, v115
    v_fmac_f32 v158, v8, v22
    v_fmac_f32 v159, v9, v22
    s_waitcnt vmcnt(12)
    v_lshlrev_b32 v23, 16, v23
    v_lshlrev_b32 v8, 16, v60
    v_and_b32 v9, 0xffff0000, v60
    v_fmac_f32 v144, v8, v23
    v_fmac_f32 v145, v9, v23
    v_lshlrev_b32 v8, 16, v61
    v_and_b32 v9, 0xffff0000, v61
    v_fmac_f32 v146, v8, v23
    v_fmac_f32 v147, v9, v23
    v_lshlrev_b32 v8, 16, v62
    v_and_b32 v9, 0xffff0000, v62
    v_fmac_f32 v148, v8, v23
    v_fmac_f32 v149, v9, v23
    v_lshlrev_b32 v8, 16, v63
    v_and_b32 v9, 0xffff0000, v63
    v_fmac_f32 v150, v8, v23
    v_fmac_f32 v151, v9, v23
    v_lshlrev_b32 v8, 16, v116
    v_and_b32 v9, 0xffff0000, v116
    v_fmac_f32 v152, v8, v23
    v_fmac_f32 v153, v9, v23
    v_lshlrev_b32 v8, 16, v117
    v_and_b32 v9, 0xffff0000, v117
    v_fmac_f32 v154, v8, v23
    v_fmac_f32 v155, v9, v23
    v_lshlrev_b32 v8, 16, v118
    v_and_b32 v9, 0xffff0000, v118
    v_fmac_f32 v156, v8, v23
    v_fmac_f32 v157, v9, v23
    v_lshlrev_b32 v8, 16, v119
    v_and_b32 v9, 0xffff0000, v119
    v_fmac_f32 v158, v8, v23
    v_fmac_f32 v159, v9, v23
    s_waitcnt vmcnt(10)
    v_lshlrev_b32 v24, 16, v24
    v_lshlrev_b32 v8, 16, v64
    v_and_b32 v9, 0xffff0000, v64
    v_fmac_f32 v144, v8, v24
    v_fmac_f32 v145, v9, v24
    v_lshlrev_b32 v8, 16, v65
    v_and_b32 v9, 0xffff0000, v65
    v_fmac_f32 v146, v8, v24
    v_fmac_f32 v147, v9, v24
    v_lshlrev_b32 v8, 16, v66
    v_and_b32 v9, 0xffff0000, v66
    v_fmac_f32 v148, v8, v24
    v_fmac_f32 v149, v9, v24
    v_lshlrev_b32 v8, 16, v67
    v_and_b32 v9, 0xffff0000, v67
    v_fmac_f32 v150, v8, v24
    v_fmac_f32 v151, v9, v24
    v_lshlrev_b32 v8, 16, v120
    v_and_b32 v9, 0xffff0000, v120
    v_fmac_f32 v152, v8, v24
    v_fmac_f32 v153, v9, v24
    v_lshlrev_b32 v8, 16, v121
    v_and_b32 v9, 0xffff0000, v121
    v_fmac_f32 v154, v8, v24
    v_fmac_f32 v155, v9, v24
    v_lshlrev_b32 v8, 16, v122
    v_and_b32 v9, 0xffff0000, v122
    v_fmac_f32 v156, v8, v24
    v_fmac_f32 v157, v9, v24
    v_lshlrev_b32 v8, 16, v123
    v_and_b32 v9, 0xffff0000, v123
    v_fmac_f32 v158, v8, v24
    v_fmac_f32 v159, v9, v24
    s_waitcnt vmcnt(8)
    v_lshlrev_b32 v25, 16, v25
    v_lshlrev_b32 v8, 16, v68
    v_and_b32 v9, 0xffff0000, v68
    v_fmac_f32 v144, v8, v25
    v_fmac_f32 v145, v9, v25
    v_lshlrev_b32 v8, 16, v69
    v_and_b32 v9, 0xffff0000, v69
    v_fmac_f32 v146, v8, v25
    v_fmac_f32 v147, v9, v25
    v_lshlrev_b32 v8, 16, v70
    v_and_b32 v9, 0xffff0000, v70
    v_fmac_f32 v148, v8, v25
    v_fmac_f32 v149, v9, v25
    v_lshlrev_b32 v8, 16, v71
    v_and_b32 v9, 0xffff0000, v71
    v_fmac_f32 v150, v8, v25
    v_fmac_f32 v151, v9, v25
    v_lshlrev_b32 v8, 16, v124
    v_and_b32 v9, 0xffff0000, v124
    v_fmac_f32 v152, v8, v25
    v_fmac_f32 v153, v9, v25
    v_lshlrev_b32 v8, 16, v125
    v_and_b32 v9, 0xffff0000, v125
    v_fmac_f32 v154, v8, v25
    v_fmac_f32 v155, v9, v25
    v_lshlrev_b32 v8, 16, v126
    v_and_b32 v9, 0xffff0000, v126
    v_fmac_f32 v156, v8, v25
    v_fmac_f32 v157, v9, v25
    v_lshlrev_b32 v8, 16, v127
    v_and_b32 v9, 0xffff0000, v127
    v_fmac_f32 v158, v8, v25
    v_fmac_f32 v159, v9, v25
    s_waitcnt vmcnt(6)
    v_lshlrev_b32 v26, 16, v26
    v_lshlrev_b32 v8, 16, v72
    v_and_b32 v9, 0xffff0000, v72
    v_fmac_f32 v144, v8, v26
    v_fmac_f32 v145, v9, v26
    v_lshlrev_b32 v8, 16, v73
    v_and_b32 v9, 0xffff0000, v73
    v_fmac_f32 v146, v8, v26
    v_fmac_f32 v147, v9, v26
    v_lshlrev_b32 v8, 16, v74
    v_and_b32 v9, 0xffff0000, v74
    v_fmac_f32 v148, v8, v26
    v_fmac_f32 v149, v9, v26
    v_lshlrev_b32 v8, 16, v75
    v_and_b32 v9, 0xffff0000, v75
    v_fmac_f32 v150, v8, v26
    v_fmac_f32 v151, v9, v26
    v_lshlrev_b32 v8, 16, v128
    v_and_b32 v9, 0xffff0000, v128
    v_fmac_f32 v152, v8, v26
    v_fmac_f32 v153, v9, v26
    v_lshlrev_b32 v8, 16, v129
    v_and_b32 v9, 0xffff0000, v129
    v_fmac_f32 v154, v8, v26
    v_fmac_f32 v155, v9, v26
    v_lshlrev_b32 v8, 16, v130
    v_and_b32 v9, 0xffff0000, v130
    v_fmac_f32 v156, v8, v26
    v_fmac_f32 v157, v9, v26
    v_lshlrev_b32 v8, 16, v131
    v_and_b32 v9, 0xffff0000, v131
    v_fmac_f32 v158, v8, v26
    v_fmac_f32 v159, v9, v26
    s_waitcnt vmcnt(4)
    v_lshlrev_b32 v27, 16, v27
    v_lshlrev_b32 v8, 16, v76
    v_and_b32 v9, 0xffff0000, v76
    v_fmac_f32 v144, v8, v27
    v_fmac_f32 v145, v9, v27
    v_lshlrev_b32 v8, 16, v77
    v_and_b32 v9, 0xffff0000, v77
    v_fmac_f32 v146, v8, v27
    v_fmac_f32 v147, v9, v27
    v_lshlrev_b32 v8, 16, v78
    v_and_b32 v9, 0xffff0000, v78
    v_fmac_f32 v148, v8, v27
    v_fmac_f32 v149, v9, v27
    v_lshlrev_b32 v8, 16, v79
    v_and_b32 v9, 0xffff0000, v79
    v_fmac_f32 v150, v8, v27
    v_fmac_f32 v151, v9, v27
    v_lshlrev_b32 v8, 16, v132
    v_and_b32 v9, 0xffff0000, v132
    v_fmac_f32 v152, v8, v27
    v_fmac_f32 v153, v9, v27
    v_lshlrev_b32 v8, 16, v133
    v_and_b32 v9, 0xffff0000, v133
    v_fmac_f32 v154, v8, v27
    v_fmac_f32 v155, v9, v27
    v_lshlrev_b32 v8, 16, v134
    v_and_b32 v9, 0xffff0000, v134
    v_fmac_f32 v156, v8, v27
    v_fmac_f32 v157, v9, v27
    v_lshlrev_b32 v8, 16, v135
    v_and_b32 v9, 0xffff0000, v135
    v_fmac_f32 v158, v8, v27
    v_fmac_f32 v159, v9, v27
    s_waitcnt vmcnt(2)
    v_lshlrev_b32 v28, 16, v28
    v_lshlrev_b32 v8, 16, v80
    v_and_b32 v9, 0xffff0000, v80
    v_fmac_f32 v144, v8, v28
    v_fmac_f32 v145, v9, v28
    v_lshlrev_b32 v8, 16, v81
    v_and_b32 v9, 0xffff0000, v81
    v_fmac_f32 v146, v8, v28
    v_fmac_f32 v147, v9, v28
    v_lshlrev_b32 v8, 16, v82
    v_and_b32 v9, 0xffff0000, v82
    v_fmac_f32 v148, v8, v28
    v_fmac_f32 v149, v9, v28
    v_lshlrev_b32 v8, 16, v83
    v_and_b32 v9, 0xffff0000, v83
    v_fmac_f32 v150, v8, v28
    v_fmac_f32 v151, v9, v28
    v_lshlrev_b32 v8, 16, v136
    v_and_b32 v9, 0xffff0000, v136
    v_fmac_f32 v152, v8, v28
    v_fmac_f32 v153, v9, v28
    v_lshlrev_b32 v8, 16, v137
    v_and_b32 v9, 0xffff0000, v137
    v_fmac_f32 v154, v8, v28
    v_fmac_f32 v155, v9, v28
    v_lshlrev_b32 v8, 16, v138
    v_and_b32 v9, 0xffff0000, v138
    v_fmac_f32 v156, v8, v28
    v_fmac_f32 v157, v9, v28
    v_lshlrev_b32 v8, 16, v139
    v_and_b32 v9, 0xffff0000, v139
    v_fmac_f32 v158, v8, v28
    v_fmac_f32 v159, v9, v28
    s_waitcnt vmcnt(0)
    v_lshlrev_b32 v29, 16, v29
    v_lshlrev_b32 v8, 16, v84
    v_and_b32 v9, 0xffff0000, v84
    v_fmac_f32 v144, v8, v29
    v_fmac_f32 v145, v9, v29
    v_lshlrev_b32 v8, 16, v85
    v_and_b32 v9, 0xffff0000, v85
    v_fmac_f32 v146, v8, v29
    v_fmac_f32 v147, v9, v29
    v_lshlrev_b32 v8, 16, v86
    v_and_b32 v9, 0xffff0000, v86
    v_fmac_f32 v148, v8, v29
    v_fmac_f32 v149, v9, v29
    v_lshlrev_b32 v8, 16, v87
    v_and_b32 v9, 0xffff0000, v87
    v_fmac_f32 v150, v8, v29
    v_fmac_f32 v151, v9, v29
    v_lshlrev_b32 v8, 16, v140
    v_and_b32 v9, 0xffff0000, v140
    v_fmac_f32 v152, v8, v29
    v_fmac_f32 v153, v9, v29
    v_lshlrev_b32 v8, 16, v141
    v_and_b32 v9, 0xffff0000, v141
    v_fmac_f32 v154, v8, v29
    v_fmac_f32 v155, v9, v29
    v_lshlrev_b32 v8, 16, v142
    v_and_b32 v9, 0xffff0000, v142
    v_fmac_f32 v156, v8, v29
    v_fmac_f32 v157, v9, v29
    v_lshlrev_b32 v8, 16, v143
    v_and_b32 v9, 0xffff0000, v143
    v_fmac_f32 v158, v8, v29
    v_fmac_f32 v159, v9, v29
    s_lshl_b32 s41, s28, 12
    v_lshlrev_b32 v8, 9, v12
    v_lshl_add_u32 v8, v13, 5, v8
    v_add_u32 v8, s41, v8
    ds_write_b128 v8, v[144:147]
    ds_write_b128 v8, v[148:151] offset:16
    ds_write_b128 v8, v[152:155] offset:256
    ds_write_b128 v8, v[156:159] offset:272
    s_lshl_b32 s41, s36, 6
    s_lshl_b32 s42, s28, 4
    s_add_u32 s41, s41, s42
    s_mul_i32 s41, s41, 896
    v_mov_b32 v9, 2147483632
    v_cmp_gt_u32 vcc, 56, v1
    s_nop 1
    v_cndmask_b32 v9, v9, v4, vcc
    buffer_load_dwordx4 v[32:35], v9, s[56:59], s41 offen
    s_add_u32 s41, s41, 896
    buffer_load_dwordx4 v[36:39], v9, s[56:59], s41 offen
    s_add_u32 s41, s41, 896
    buffer_load_dwordx4 v[40:43], v9, s[56:59], s41 offen
    s_add_u32 s41, s41, 896
    buffer_load_dwordx4 v[44:47], v9, s[56:59], s41 offen
    s_add_u32 s41, s41, 896
    buffer_load_dwordx4 v[48:51], v9, s[56:59], s41 offen
    s_add_u32 s41, s41, 896
    buffer_load_dwordx4 v[52:55], v9, s[56:59], s41 offen
    s_add_u32 s41, s41, 896
    buffer_load_dwordx4 v[56:59], v9, s[56:59], s41 offen
    s_add_u32 s41, s41, 896
    buffer_load_dwordx4 v[60:63], v9, s[56:59], s41 offen
    s_add_u32 s41, s41, 896
    buffer_load_dwordx4 v[64:67], v9, s[56:59], s41 offen
    s_add_u32 s41, s41, 896
    buffer_load_dwordx4 v[68:71], v9, s[56:59], s41 offen
    s_add_u32 s41, s41, 896
    buffer_load_dwordx4 v[72:75], v9, s[56:59], s41 offen
    s_add_u32 s41, s41, 896
    buffer_load_dwordx4 v[76:79], v9, s[56:59], s41 offen
    s_add_u32 s41, s41, 896
    buffer_load_dwordx4 v[80:83], v9, s[56:59], s41 offen
    s_add_u32 s41, s41, 896
    buffer_load_dwordx4 v[84:87], v9, s[56:59], s41 offen
    s_add_u32 s41, s41, 896
    buffer_load_dwordx4 v[88:91], v9, s[56:59], s41 offen
    s_add_u32 s41, s41, 896
    buffer_load_dwordx4 v[92:95], v9, s[56:59], s41 offen
    s_add_u32 s41, s41, 896
    s_waitcnt lgkmcnt(0)
    s_barrier
    v_lshlrev_b32 v10, 2, v1
    v_mov_b32 v12, 0
    v_mov_b32 v13, 0
    ds_read2_b32 v[100:101], v10 offset0:0 offset1:64
    v_add_u32 v10, 512, v10
    ds_read2_b32 v[102:103], v10 offset0:0 offset1:64
    v_add_u32 v10, 512, v10
    ds_read2_b32 v[104:105], v10 offset0:0 offset1:64
    v_add_u32 v10, 512, v10
    ds_read2_b32 v[106:107], v10 offset0:0 offset1:64
    v_add_u32 v10, 512, v10
    ds_read2_b32 v[108:109], v10 offset0:0 offset1:64
    v_add_u32 v10, 512, v10
    ds_read2_b32 v[110:111], v10 offset0:0 offset1:64
    v_add_u32 v10, 512, v10
    ds_read2_b32 v[112:113], v10 offset0:0 offset1:64
    v_add_u32 v10, 512, v10
    ds_read2_b32 v[114:115], v10 offset0:0 offset1:64
    v_add_u32 v10, 512, v10
    s_waitcnt lgkmcnt(0)
    v_add_f32 v12, v12, v100
    v_add_f32 v13, v13, v101
    v_add_f32 v12, v12, v102
    v_add_f32 v13, v13, v103
    v_add_f32 v12, v12, v104
    v_add_f32 v13, v13, v105
    v_add_f32 v12, v12, v106
    v_add_f32 v13, v13, v107
    v_add_f32 v12, v12, v108
    v_add_f32 v13, v13, v109
    v_add_f32 v12, v12, v110
    v_add_f32 v13, v13, v111
    v_add_f32 v12, v12, v112
    v_add_f32 v13, v13, v113
    v_add_f32 v12, v12, v114
    v_add_f32 v13, v13, v115
    ds_read2_b32 v[100:101], v10 offset0:0 offset1:64
    v_add_u32 v10, 512, v10
    ds_read2_b32 v[102:103], v10 offset0:0 offset1:64
    v_add_u32 v10, 512, v10
    ds_read2_b32 v[104:105], v10 offset0:0 offset1:64
    v_add_u32 v10, 512, v10
    ds_read2_b32 v[106:107], v10 offset0:0 offset1:64
    v_add_u32 v10, 512, v10
    ds_read2_b32 v[108:109], v10 offset0:0 offset1:64
    v_add_u32 v10, 512, v10
    ds_read2_b32 v[110:111], v10 offset0:0 offset1:64
    v_add_u32 v10, 512, v10
    ds_read2_b32 v[112:113], v10 offset0:0 offset1:64
    v_add_u32 v10, 512, v10
    ds_read2_b32 v[114:115], v10 offset0:0 offset1:64
    v_add_u32 v10, 512, v10
    s_waitcnt lgkmcnt(0)
    v_add_f32 v12, v12, v100
    v_add_f32 v13, v13, v101
    v_add_f32 v12, v12, v102
    v_add_f32 v13, v13, v103
    v_add_f32 v12, v12, v104
    v_add_f32 v13, v13, v105
    v_add_f32 v12, v12, v106
    v_add_f32 v13, v13, v107
    v_add_f32 v12, v12, v108
    v_add_f32 v13, v13, v109
    v_add_f32 v12, v12, v110
    v_add_f32 v13, v13, v111
    v_add_f32 v12, v12, v112
    v_add_f32 v13, v13, v113
    v_add_f32 v12, v12, v114
    v_add_f32 v13, v13, v115
    ds_read2_b32 v[100:101], v10 offset0:0 offset1:64
    v_add_u32 v10, 512, v10
    ds_read2_b32 v[102:103], v10 offset0:0 offset1:64
    v_add_u32 v10, 512, v10
    ds_read2_b32 v[104:105], v10 offset0:0 offset1:64
    v_add_u32 v10, 512, v10
    ds_read2_b32 v[106:107], v10 offset0:0 offset1:64
    v_add_u32 v10, 512, v10
    ds_read2_b32 v[108:109], v10 offset0:0 offset1:64
    v_add_u32 v10, 512, v10
    ds_read2_b32 v[110:111], v10 offset0:0 offset1:64
    v_add_u32 v10, 512, v10
    ds_read2_b32 v[112:113], v10 offset0:0 offset1:64
    v_add_u32 v10, 512, v10
    ds_read2_b32 v[114:115], v10 offset0:0 offset1:64
    v_add_u32 v10, 512, v10
    s_waitcnt lgkmcnt(0)
    v_add_f32 v12, v12, v100
    v_add_f32 v13, v13, v101
    v_add_f32 v12, v12, v102
    v_add_f32 v13, v13, v103
    v_add_f32 v12, v12, v104
    v_add_f32 v13, v13, v105
    v_add_f32 v12, v12, v106
    v_add_f32 v13, v13, v107
    v_add_f32 v12, v12, v108
    v_add_f32 v13, v13, v109
    v_add_f32 v12, v12, v110
    v_add_f32 v13, v13, v111
    v_add_f32 v12, v12, v112
    v_add_f32 v13, v13, v113
    v_add_f32 v12, v12, v114
    v_add_f32 v13, v13, v115
    ds_read2_b32 v[100:101], v10 offset0:0 offset1:64
    v_add_u32 v10, 512, v10
    ds_read2_b32 v[102:103], v10 offset0:0 offset1:64
    v_add_u32 v10, 512, v10
    ds_read2_b32 v[104:105], v10 offset0:0 offset1:64
    v_add_u32 v10, 512, v10
    ds_read2_b32 v[106:107], v10 offset0:0 offset1:64
    v_add_u32 v10, 512, v10
    ds_read2_b32 v[108:109], v10 offset0:0 offset1:64
    v_add_u32 v10, 512, v10
    ds_read2_b32 v[110:111], v10 offset0:0 offset1:64
    v_add_u32 v10, 512, v10
    ds_read2_b32 v[112:113], v10 offset0:0 offset1:64
    v_add_u32 v10, 512, v10
    ds_read2_b32 v[114:115], v10 offset0:0 offset1:64
    v_add_u32 v10, 512, v10
    s_waitcnt lgkmcnt(0)
    v_add_f32 v12, v12, v100
    v_add_f32 v13, v13, v101
    v_add_f32 v12, v12, v102
    v_add_f32 v13, v13, v103
    v_add_f32 v12, v12, v104
    v_add_f32 v13, v13, v105
    v_add_f32 v12, v12, v106
    v_add_f32 v13, v13, v107
    v_add_f32 v12, v12, v108
    v_add_f32 v13, v13, v109
    v_add_f32 v12, v12, v110
    v_add_f32 v13, v13, v111
    v_add_f32 v12, v12, v112
    v_add_f32 v13, v13, v113
    v_add_f32 v12, v12, v114
    v_add_f32 v13, v13, v115
    v_cvt_pk_bf16_f32 v12, v12, v12
    v_and_b32 v12, 0xffff0000, v12
    v_cvt_pk_bf16_f32 v13, v13, v13
    v_and_b32 v13, 0xffff0000, v13
    v_mul_f32 v14, 0xbfb8aa3b, v12
    v_exp_f32 v14, v14
    s_nop 0
    v_add_f32 v14, 1.0, v14
    v_rcp_f32 v14, v14
    s_nop 0
    v_mul_f32 v12, v12, v14
    v_cvt_pk_bf16_f32 v12, v12, v12
    v_and_b32 v12, 0xffff0000, v12
    v_mul_f32 v12, v12, v13
    v_cvt_pk_bf16_f32 v12, v12, v12
    v_and_b32 v12, 0xffff0000, v12
    s_lshl_b32 s42, s28, 4
    v_mov_b32 v144, 0
    v_mov_b32 v145, 0
    v_mov_b32 v146, 0
    v_mov_b32 v147, 0
    v_mov_b32 v148, 0
    v_mov_b32 v149, 0
    v_mov_b32 v150, 0
    v_mov_b32 v151, 0
    s_add_u32 s43, s42, 0
    v_readlane_b32 s41, v12, s43
    s_waitcnt vmcnt(15)
    v_lshlrev_b32 v8, 16, v32
    v_and_b32 v9, 0xffff0000, v32
    v_fmac_f32 v144, s41, v8
    v_fmac_f32 v145, s41, v9
    v_lshlrev_b32 v8, 16, v33
    v_and_b32 v9, 0xffff0000, v33
    v_fmac_f32 v146, s41, v8
    v_fmac_f32 v147, s41, v9
    v_lshlrev_b32 v8, 16, v34
    v_and_b32 v9, 0xffff0000, v34
    v_fmac_f32 v148, s41, v8
    v_fmac_f32 v149, s41, v9
    v_lshlrev_b32 v8, 16, v35
    v_and_b32 v9, 0xffff0000, v35
    v_fmac_f32 v150, s41, v8
    v_fmac_f32 v151, s41, v9
    s_add_u32 s43, s42, 1
    v_readlane_b32 s41, v12, s43
    s_waitcnt vmcnt(14)
    v_lshlrev_b32 v8, 16, v36
    v_and_b32 v9, 0xffff0000, v36
    v_fmac_f32 v144, s41, v8
    v_fmac_f32 v145, s41, v9
    v_lshlrev_b32 v8, 16, v37
    v_and_b32 v9, 0xffff0000, v37
    v_fmac_f32 v146, s41, v8
    v_fmac_f32 v147, s41, v9
    v_lshlrev_b32 v8, 16, v38
    v_and_b32 v9, 0xffff0000, v38
    v_fmac_f32 v148, s41, v8
    v_fmac_f32 v149, s41, v9
    v_lshlrev_b32 v8, 16, v39
    v_and_b32 v9, 0xffff0000, v39
    v_fmac_f32 v150, s41, v8
    v_fmac_f32 v151, s41, v9
    s_add_u32 s43, s42, 2
    v_readlane_b32 s41, v12, s43
    s_waitcnt vmcnt(13)
    v_lshlrev_b32 v8, 16, v40
    v_and_b32 v9, 0xffff0000, v40
    v_fmac_f32 v144, s41, v8
    v_fmac_f32 v145, s41, v9
    v_lshlrev_b32 v8, 16, v41
    v_and_b32 v9, 0xffff0000, v41
    v_fmac_f32 v146, s41, v8
    v_fmac_f32 v147, s41, v9
    v_lshlrev_b32 v8, 16, v42
    v_and_b32 v9, 0xffff0000, v42
    v_fmac_f32 v148, s41, v8
    v_fmac_f32 v149, s41, v9
    v_lshlrev_b32 v8, 16, v43
    v_and_b32 v9, 0xffff0000, v43
    v_fmac_f32 v150, s41, v8
    v_fmac_f32 v151, s41, v9
    s_add_u32 s43, s42, 3
    v_readlane_b32 s41, v12, s43
    s_waitcnt vmcnt(12)
    v_lshlrev_b32 v8, 16, v44
    v_and_b32 v9, 0xffff0000, v44
    v_fmac_f32 v144, s41, v8
    v_fmac_f32 v145, s41, v9
    v_lshlrev_b32 v8, 16, v45
    v_and_b32 v9, 0xffff0000, v45
    v_fmac_f32 v146, s41, v8
    v_fmac_f32 v147, s41, v9
    v_lshlrev_b32 v8, 16, v46
    v_and_b32 v9, 0xffff0000, v46
    v_fmac_f32 v148, s41, v8
    v_fmac_f32 v149, s41, v9
    v_lshlrev_b32 v8, 16, v47
    v_and_b32 v9, 0xffff0000, v47
    v_fmac_f32 v150, s41, v8
    v_fmac_f32 v151, s41, v9
    s_add_u32 s43, s42, 4
    v_readlane_b32 s41, v12, s43
    s_waitcnt vmcnt(11)
    v_lshlrev_b32 v8, 16, v48
    v_and_b32 v9, 0xffff0000, v48
    v_fmac_f32 v144, s41, v8
    v_fmac_f32 v145, s41, v9
    v_lshlrev_b32 v8, 16, v49
    v_and_b32 v9, 0xffff0000, v49
    v_fmac_f32 v146, s41, v8
    v_fmac_f32 v147, s41, v9
    v_lshlrev_b32 v8, 16, v50
    v_and_b32 v9, 0xffff0000, v50
    v_fmac_f32 v148, s41, v8
    v_fmac_f32 v149, s41, v9
    v_lshlrev_b32 v8, 16, v51
    v_and_b32 v9, 0xffff0000, v51
    v_fmac_f32 v150, s41, v8
    v_fmac_f32 v151, s41, v9
    s_add_u32 s43, s42, 5
    v_readlane_b32 s41, v12, s43
    s_waitcnt vmcnt(10)
    v_lshlrev_b32 v8, 16, v52
    v_and_b32 v9, 0xffff0000, v52
    v_fmac_f32 v144, s41, v8
    v_fmac_f32 v145, s41, v9
    v_lshlrev_b32 v8, 16, v53
    v_and_b32 v9, 0xffff0000, v53
    v_fmac_f32 v146, s41, v8
    v_fmac_f32 v147, s41, v9
    v_lshlrev_b32 v8, 16, v54
    v_and_b32 v9, 0xffff0000, v54
    v_fmac_f32 v148, s41, v8
    v_fmac_f32 v149, s41, v9
    v_lshlrev_b32 v8, 16, v55
    v_and_b32 v9, 0xffff0000, v55
    v_fmac_f32 v150, s41, v8
    v_fmac_f32 v151, s41, v9
    s_add_u32 s43, s42, 6
    v_readlane_b32 s41, v12, s43
    s_waitcnt vmcnt(9)
    v_lshlrev_b32 v8, 16, v56
    v_and_b32 v9, 0xffff0000, v56
    v_fmac_f32 v144, s41, v8
    v_fmac_f32 v145, s41, v9
    v_lshlrev_b32 v8, 16, v57
    v_and_b32 v9, 0xffff0000, v57
    v_fmac_f32 v146, s41, v8
    v_fmac_f32 v147, s41, v9
    v_lshlrev_b32 v8, 16, v58
    v_and_b32 v9, 0xffff0000, v58
    v_fmac_f32 v148, s41, v8
    v_fmac_f32 v149, s41, v9
    v_lshlrev_b32 v8, 16, v59
    v_and_b32 v9, 0xffff0000, v59
    v_fmac_f32 v150, s41, v8
    v_fmac_f32 v151, s41, v9
    s_add_u32 s43, s42, 7
    v_readlane_b32 s41, v12, s43
    s_waitcnt vmcnt(8)
    v_lshlrev_b32 v8, 16, v60
    v_and_b32 v9, 0xffff0000, v60
    v_fmac_f32 v144, s41, v8
    v_fmac_f32 v145, s41, v9
    v_lshlrev_b32 v8, 16, v61
    v_and_b32 v9, 0xffff0000, v61
    v_fmac_f32 v146, s41, v8
    v_fmac_f32 v147, s41, v9
    v_lshlrev_b32 v8, 16, v62
    v_and_b32 v9, 0xffff0000, v62
    v_fmac_f32 v148, s41, v8
    v_fmac_f32 v149, s41, v9
    v_lshlrev_b32 v8, 16, v63
    v_and_b32 v9, 0xffff0000, v63
    v_fmac_f32 v150, s41, v8
    v_fmac_f32 v151, s41, v9
    s_add_u32 s43, s42, 8
    v_readlane_b32 s41, v12, s43
    s_waitcnt vmcnt(7)
    v_lshlrev_b32 v8, 16, v64
    v_and_b32 v9, 0xffff0000, v64
    v_fmac_f32 v144, s41, v8
    v_fmac_f32 v145, s41, v9
    v_lshlrev_b32 v8, 16, v65
    v_and_b32 v9, 0xffff0000, v65
    v_fmac_f32 v146, s41, v8
    v_fmac_f32 v147, s41, v9
    v_lshlrev_b32 v8, 16, v66
    v_and_b32 v9, 0xffff0000, v66
    v_fmac_f32 v148, s41, v8
    v_fmac_f32 v149, s41, v9
    v_lshlrev_b32 v8, 16, v67
    v_and_b32 v9, 0xffff0000, v67
    v_fmac_f32 v150, s41, v8
    v_fmac_f32 v151, s41, v9
    s_add_u32 s43, s42, 9
    v_readlane_b32 s41, v12, s43
    s_waitcnt vmcnt(6)
    v_lshlrev_b32 v8, 16, v68
    v_and_b32 v9, 0xffff0000, v68
    v_fmac_f32 v144, s41, v8
    v_fmac_f32 v145, s41, v9
    v_lshlrev_b32 v8, 16, v69
    v_and_b32 v9, 0xffff0000, v69
    v_fmac_f32 v146, s41, v8
    v_fmac_f32 v147, s41, v9
    v_lshlrev_b32 v8, 16, v70
    v_and_b32 v9, 0xffff0000, v70
    v_fmac_f32 v148, s41, v8
    v_fmac_f32 v149, s41, v9
    v_lshlrev_b32 v8, 16, v71
    v_and_b32 v9, 0xffff0000, v71
    v_fmac_f32 v150, s41, v8
    v_fmac_f32 v151, s41, v9
    s_add_u32 s43, s42, 10
    v_readlane_b32 s41, v12, s43
    s_waitcnt vmcnt(5)
    v_lshlrev_b32 v8, 16, v72
    v_and_b32 v9, 0xffff0000, v72
    v_fmac_f32 v144, s41, v8
    v_fmac_f32 v145, s41, v9
    v_lshlrev_b32 v8, 16, v73
    v_and_b32 v9, 0xffff0000, v73
    v_fmac_f32 v146, s41, v8
    v_fmac_f32 v147, s41, v9
    v_lshlrev_b32 v8, 16, v74
    v_and_b32 v9, 0xffff0000, v74
    v_fmac_f32 v148, s41, v8
    v_fmac_f32 v149, s41, v9
    v_lshlrev_b32 v8, 16, v75
    v_and_b32 v9, 0xffff0000, v75
    v_fmac_f32 v150, s41, v8
    v_fmac_f32 v151, s41, v9
    s_add_u32 s43, s42, 11
    v_readlane_b32 s41, v12, s43
    s_waitcnt vmcnt(4)
    v_lshlrev_b32 v8, 16, v76
    v_and_b32 v9, 0xffff0000, v76
    v_fmac_f32 v144, s41, v8
    v_fmac_f32 v145, s41, v9
    v_lshlrev_b32 v8, 16, v77
    v_and_b32 v9, 0xffff0000, v77
    v_fmac_f32 v146, s41, v8
    v_fmac_f32 v147, s41, v9
    v_lshlrev_b32 v8, 16, v78
    v_and_b32 v9, 0xffff0000, v78
    v_fmac_f32 v148, s41, v8
    v_fmac_f32 v149, s41, v9
    v_lshlrev_b32 v8, 16, v79
    v_and_b32 v9, 0xffff0000, v79
    v_fmac_f32 v150, s41, v8
    v_fmac_f32 v151, s41, v9
    s_add_u32 s43, s42, 12
    v_readlane_b32 s41, v12, s43
    s_waitcnt vmcnt(3)
    v_lshlrev_b32 v8, 16, v80
    v_and_b32 v9, 0xffff0000, v80
    v_fmac_f32 v144, s41, v8
    v_fmac_f32 v145, s41, v9
    v_lshlrev_b32 v8, 16, v81
    v_and_b32 v9, 0xffff0000, v81
    v_fmac_f32 v146, s41, v8
    v_fmac_f32 v147, s41, v9
    v_lshlrev_b32 v8, 16, v82
    v_and_b32 v9, 0xffff0000, v82
    v_fmac_f32 v148, s41, v8
    v_fmac_f32 v149, s41, v9
    v_lshlrev_b32 v8, 16, v83
    v_and_b32 v9, 0xffff0000, v83
    v_fmac_f32 v150, s41, v8
    v_fmac_f32 v151, s41, v9
    s_add_u32 s43, s42, 13
    v_readlane_b32 s41, v12, s43
    s_waitcnt vmcnt(2)
    v_lshlrev_b32 v8, 16, v84
    v_and_b32 v9, 0xffff0000, v84
    v_fmac_f32 v144, s41, v8
    v_fmac_f32 v145, s41, v9
    v_lshlrev_b32 v8, 16, v85
    v_and_b32 v9, 0xffff0000, v85
    v_fmac_f32 v146, s41, v8
    v_fmac_f32 v147, s41, v9
    v_lshlrev_b32 v8, 16, v86
    v_and_b32 v9, 0xffff0000, v86
    v_fmac_f32 v148, s41, v8
    v_fmac_f32 v149, s41, v9
    v_lshlrev_b32 v8, 16, v87
    v_and_b32 v9, 0xffff0000, v87
    v_fmac_f32 v150, s41, v8
    v_fmac_f32 v151, s41, v9
    s_add_u32 s43, s42, 14
    v_readlane_b32 s41, v12, s43
    s_waitcnt vmcnt(1)
    v_lshlrev_b32 v8, 16, v88
    v_and_b32 v9, 0xffff0000, v88
    v_fmac_f32 v144, s41, v8
    v_fmac_f32 v145, s41, v9
    v_lshlrev_b32 v8, 16, v89
    v_and_b32 v9, 0xffff0000, v89
    v_fmac_f32 v146, s41, v8
    v_fmac_f32 v147, s41, v9
    v_lshlrev_b32 v8, 16, v90
    v_and_b32 v9, 0xffff0000, v90
    v_fmac_f32 v148, s41, v8
    v_fmac_f32 v149, s41, v9
    v_lshlrev_b32 v8, 16, v91
    v_and_b32 v9, 0xffff0000, v91
    v_fmac_f32 v150, s41, v8
    v_fmac_f32 v151, s41, v9
    s_add_u32 s43, s42, 15
    v_readlane_b32 s41, v12, s43
    s_waitcnt vmcnt(0)
    v_lshlrev_b32 v8, 16, v92
    v_and_b32 v9, 0xffff0000, v92
    v_fmac_f32 v144, s41, v8
    v_fmac_f32 v145, s41, v9
    v_lshlrev_b32 v8, 16, v93
    v_and_b32 v9, 0xffff0000, v93
    v_fmac_f32 v146, s41, v8
    v_fmac_f32 v147, s41, v9
    v_lshlrev_b32 v8, 16, v94
    v_and_b32 v9, 0xffff0000, v94
    v_fmac_f32 v148, s41, v8
    v_fmac_f32 v149, s41, v9
    v_lshlrev_b32 v8, 16, v95
    v_and_b32 v9, 0xffff0000, v95
    v_fmac_f32 v150, s41, v8
    v_fmac_f32 v151, s41, v9
    s_barrier
    s_lshl_b32 s41, s28, 11
    v_lshlrev_b32 v8, 5, v1
    v_add_u32 v9, s41, v8
    ds_write_b128 v9, v[144:147]
    ds_write_b128 v9, v[148:151] offset:16
    s_waitcnt lgkmcnt(0)
    s_barrier
    s_cmp_lg_u32 s28, 0
    s_cbranch_scc1 H_mod_done
    ds_read_b128 v[108:111], v8 offset:2048
    ds_read_b128 v[112:115], v8 offset:2064
    ds_read_b128 v[116:119], v8 offset:4096
    ds_read_b128 v[120:123], v8 offset:4112
    ds_read_b128 v[124:127], v8 offset:6144
    ds_read_b128 v[128:131], v8 offset:6160
    s_waitcnt lgkmcnt(0)
    v_add_f32 v144, v144, v108
    v_add_f32 v145, v145, v109
    v_add_f32 v146, v146, v110
    v_add_f32 v147, v147, v111
    v_add_f32 v148, v148, v112
    v_add_f32 v149, v149, v113
    v_add_f32 v150, v150, v114
    v_add_f32 v151, v151, v115
    v_add_f32 v144, v144, v116
    v_add_f32 v145, v145, v117
    v_add_f32 v146, v146, v118
    v_add_f32 v147, v147, v119
    v_add_f32 v148, v148, v120
    v_add_f32 v149, v149, v121
    v_add_f32 v150, v150, v122
    v_add_f32 v151, v151, v123
    v_add_f32 v144, v144, v124
    v_add_f32 v145, v145, v125
    v_add_f32 v146, v146, v126
    v_add_f32 v147, v147, v127
    v_add_f32 v148, v148, v128
    v_add_f32 v149, v149, v129
    v_add_f32 v150, v150, v130
    v_add_f32 v151, v151, v131
    v_mov_b32 v9, 2147483632
    v_cmp_gt_u32 vcc, 56, v1
    s_nop 1
    v_cndmask_b32 v9, v9, v8, vcc
    s_mul_i32 s41, s36, 1792
    s_add_u32 s41, s41, 95059968
    buffer_store_dwordx4 v[144:147], v9, s[16:19], s41 offen sc1
    buffer_store_dwordx4 v[148:151], v9, s[16:19], s41 offen offset:16 sc1
    v_mov_b32 v10, s60
    v_mov_b32 v11, s61
    v_mov_b32 v12, 32
    v_mov_b32 v13, 28
    v_mov_b32 v14, 1
    s_mov_b64 exec, 1
    buffer_store_dwordx2 v[10:11], v12, s[16:19], s37 offen sc1
    s_waitcnt vmcnt(0)
    buffer_store_dword v14, v13, s[16:19], s37 offen sc1
    s_mov_b64 exec, -1
H_mod_done:
    s_barrier
H_phase2:
    s_cmp_eq_u32 s28, 0
    s_cbranch_scc1 H_vp
    s_cmp_eq_u32 s28, 3
    s_cbranch_scc1 H_f2
    s_sub_u32 s47, s28, 1
    s_mov_b32 s45, s35
    s_mov_b32 s46, 0
    s_lshl_b32 s41, s47, 4
    v_add_u32 v16, s41, v3
    v_lshlrev_b32 v17, 2, v2
    v_mov_b32 v18, 0xf149f2ca
    v_add_u32 v19, 0, v17
    v_cmp_le_u32 vcc, v19, v16
    s_nop 1
    v_cndmask_b32 v8, v18, 0, vcc
    v_add_u32 v19, 1, v17
    v_cmp_le_u32 vcc, v19, v16
    s_nop 1
    v_cndmask_b32 v9, v18, 0, vcc
    v_add_u32 v19, 2, v17
    v_cmp_le_u32 vcc, v19, v16
    s_nop 1
    v_cndmask_b32 v10, v18, 0, vcc
    v_add_u32 v19, 3, v17
    v_cmp_le_u32 vcc, v19, v16
    s_nop 1
    v_cndmask_b32 v11, v18, 0, vcc
    v_add_u32 v19, 16, v17
    v_cmp_le_u32 vcc, v19, v16
    s_nop 1
    v_cndmask_b32 v12, v18, 0, vcc
    v_add_u32 v19, 17, v17
    v_cmp_le_u32 vcc, v19, v16
    s_nop 1
    v_cndmask_b32 v13, v18, 0, vcc
    v_add_u32 v19, 18, v17
    v_cmp_le_u32 vcc, v19, v16
    s_nop 1
    v_cndmask_b32 v14, v18, 0, vcc
    v_add_u32 v19, 19, v17
    v_cmp_le_u32 vcc, v19, v16
    s_nop 1
    v_cndmask_b32 v15, v18, 0, vcc
    s_lshl_b32 s41, s28, 13
    v_add_u32 v253, s41, v4
    v_lshrrev_b32 v16, 1, v2
    v_lshlrev_b32 v16, 8, v16
    v_lshrrev_b32 v17, 1, v3
    v_lshl_add_u32 v16, v17, 5, v16
    v_and_b32 v17, 1, v2
    v_lshl_add_u32 v16, v17, 3, v16
    v_add_u32 v254, s41, v16
    s_and_b32 s41, s34, 1
    s_lshl_b32 s41, s41, 3
    v_add_u32 v255, s41, v4
    v_min_u32 v16, 13, v1
    s_mul_i32 s41, s34, 14
    v_add_u32 v16, s41, v16
    v_lshlrev_b32 v16, 6, v16
    v_add_u32 v252, 73269248, v16
    s_lshl_b32 s41, s47, 2
    s_add_u32 s41, s41, 20
    v_mov_b32 v7, s41
H_f1_step:
    s_and_b32 s41, s45, 3
    s_lshl_b32 s41, s41, 2
    v_add_u32 v240, s41, v252
    s_lshr_b32 s41, s45, 2
    v_mov_b32 v241, s41
    s_mov_b32 s32, s31
fw_3:
    buffer_load_dword v242, v240, s[16:19], 0 offen sc1
    s_waitcnt vmcnt(0)
    v_cmp_lt_u32 vcc, v241, v242
    s_nop 0
    s_cmp_eq_u64 vcc, -1
    s_cbranch_scc1 fgo_4
    s_sleep 8
    s_sub_u32 s32, s32, 1
    s_cmp_lg_u32 s32, 0
    s_cbranch_scc1 fw_3
    s_mov_b32 s31, 1
fgo_4:
    s_lshl_b32 s41, s45, 4
    s_add_u32 s41, s41, s34
    s_mul_i32 s41, s41, 28672
    s_lshl_b32 s42, s47, 10
    s_add_u32 s41, s41, s42
    s_add_u32 s41, s41, 42205184
    s_mul_i32 s42, s45, 28672
    s_add_u32 s42, s42, 75382784
    s_add_u32 s43, s42, 14336
    buffer_load_dwordx4 v[16:19], v4, s[16:19], s41 offen offset:0 sc1
    buffer_load_dwordx4 v[72:75], v4, s[16:19], s42 offen offset:0 sc1
    buffer_load_dwordx4 v[76:79], v4, s[16:19], s43 offen offset:0 sc1
    buffer_load_dwordx4 v[20:23], v4, s[16:19], s41 offen offset:2048 sc1
    buffer_load_dwordx4 v[80:83], v4, s[16:19], s42 offen offset:1024 sc1
    buffer_load_dwordx4 v[84:87], v4, s[16:19], s43 offen offset:1024 sc1
    s_add_u32 s41, s41, 4096
    buffer_load_dwordx4 v[24:27], v4, s[16:19], s41 offen offset:0 sc1
    buffer_load_dwordx4 v[88:91], v4, s[16:19], s42 offen offset:2048 sc1
    buffer_load_dwordx4 v[92:95], v4, s[16:19], s43 offen offset:2048 sc1
    buffer_load_dwordx4 v[28:31], v4, s[16:19], s41 offen offset:2048 sc1
    buffer_load_dwordx4 v[96:99], v4, s[16:19], s42 offen offset:3072 sc1
    buffer_load_dwordx4 v[100:103], v4, s[16:19], s43 offen offset:3072 sc1
    s_add_u32 s41, s41, 4096
    s_add_u32 s42, s42, 4096
    s_add_u32 s43, s43, 4096
    buffer_load_dwordx4 v[32:35], v4, s[16:19], s41 offen offset:0 sc1
    buffer_load_dwordx4 v[104:107], v4, s[16:19], s42 offen offset:0 sc1
    buffer_load_dwordx4 v[108:111], v4, s[16:19], s43 offen offset:0 sc1
    buffer_load_dwordx4 v[36:39], v4, s[16:19], s41 offen offset:2048 sc1
    buffer_load_dwordx4 v[112:115], v4, s[16:19], s42 offen offset:1024 sc1
    buffer_load_dwordx4 v[116:119], v4, s[16:19], s43 offen offset:1024 sc1
    s_add_u32 s41, s41, 4096
    buffer_load_dwordx4 v[40:43], v4, s[16:19], s41 offen offset:0 sc1
    buffer_load_dwordx4 v[120:123], v4, s[16:19], s42 offen offset:2048 sc1
    buffer_load_dwordx4 v[124:127], v4, s[16:19], s43 offen offset:2048 sc1
    buffer_load_dwordx4 v[44:47], v4, s[16:19], s41 offen offset:2048 sc1
    buffer_load_dwordx4 v[128:131], v4, s[16:19], s42 offen offset:3072 sc1
    buffer_load_dwordx4 v[132:135], v4, s[16:19], s43 offen offset:3072 sc1
    s_add_u32 s41, s41, 4096
    s_add_u32 s42, s42, 4096
    s_add_u32 s43, s43, 4096
    buffer_load_dwordx4 v[48:51], v4, s[16:19], s41 offen offset:0 sc1
    buffer_load_dwordx4 v[136:139], v4, s[16:19], s42 offen offset:0 sc1
    buffer_load_dwordx4 v[140:143], v4, s[16:19], s43 offen offset:0 sc1
    buffer_load_dwordx4 v[52:55], v4, s[16:19], s41 offen offset:2048 sc1
    buffer_load_dwordx4 v[144:147], v4, s[16:19], s42 offen offset:1024 sc1
    buffer_load_dwordx4 v[148:151], v4, s[16:19], s43 offen offset:1024 sc1
    s_add_u32 s41, s41, 4096
    buffer_load_dwordx4 v[56:59], v4, s[16:19], s41 offen offset:0 sc1
    buffer_load_dwordx4 v[152:155], v4, s[16:19], s42 offen offset:2048 sc1
    buffer_load_dwordx4 v[156:159], v4, s[16:19], s43 offen offset:2048 sc1
    buffer_load_dwordx4 v[60:63], v4, s[16:19], s41 offen offset:2048 sc1
    buffer_load_dwordx4 v[160:163], v4, s[16:19], s42 offen offset:3072 sc1
    buffer_load_dwordx4 v[164:167], v4, s[16:19], s43 offen offset:3072 sc1
    s_add_u32 s41, s41, 4096
    s_add_u32 s42, s42, 4096
    s_add_u32 s43, s43, 4096
    buffer_load_dwordx4 v[64:67], v4, s[16:19], s41 offen offset:0 sc1
    buffer_load_dwordx4 v[168:171], v4, s[16:19], s42 offen offset:0 sc1
    buffer_load_dwordx4 v[172:175], v4, s[16:19], s43 offen offset:0 sc1
    buffer_load_dwordx4 v[68:71], v4, s[16:19], s41 offen offset:2048 sc1
    buffer_load_dwordx4 v[176:179], v4, s[16:19], s42 offen offset:1024 sc1
    buffer_load_dwordx4 v[180:183], v4, s[16:19], s43 offen offset:1024 sc1
    s_add_u32 s41, s41, 4096
    s_waitcnt vmcnt(39)
    v_mfma_f32_16x16x32_bf16 v[240:243], v[72:75], v[16:19], v[8:11]
    v_mfma_f32_16x16x32_bf16 v[244:247], v[76:79], v[16:19], v[12:15]
    s_waitcnt vmcnt(36)
    v_mfma_f32_16x16x32_bf16 v[240:243], v[80:83], v[20:23], v[240:243]
    v_mfma_f32_16x16x32_bf16 v[244:247], v[84:87], v[20:23], v[244:247]
    s_waitcnt vmcnt(33)
    v_mfma_f32_16x16x32_bf16 v[240:243], v[88:91], v[24:27], v[240:243]
    v_mfma_f32_16x16x32_bf16 v[244:247], v[92:95], v[24:27], v[244:247]
    s_waitcnt vmcnt(30)
    v_mfma_f32_16x16x32_bf16 v[240:243], v[96:99], v[28:31], v[240:243]
    v_mfma_f32_16x16x32_bf16 v[244:247], v[100:103], v[28:31], v[244:247]
    s_waitcnt vmcnt(27)
    v_mfma_f32_16x16x32_bf16 v[240:243], v[104:107], v[32:35], v[240:243]
    v_mfma_f32_16x16x32_bf16 v[244:247], v[108:111], v[32:35], v[244:247]
    s_waitcnt vmcnt(24)
    v_mfma_f32_16x16x32_bf16 v[240:243], v[112:115], v[36:39], v[240:243]
    v_mfma_f32_16x16x32_bf16 v[244:247], v[116:119], v[36:39], v[244:247]
    s_waitcnt vmcnt(21)
    v_mfma_f32_16x16x32_bf16 v[240:243], v[120:123], v[40:43], v[240:243]
    v_mfma_f32_16x16x32_bf16 v[244:247], v[124:127], v[40:43], v[244:247]
    s_waitcnt vmcnt(18)
    v_mfma_f32_16x16x32_bf16 v[240:243], v[128:131], v[44:47], v[240:243]
    v_mfma_f32_16x16x32_bf16 v[244:247], v[132:135], v[44:47], v[244:247]
    s_waitcnt vmcnt(15)
    v_mfma_f32_16x16x32_bf16 v[240:243], v[136:139], v[48:51], v[240:243]
    v_mfma_f32_16x16x32_bf16 v[244:247], v[140:143], v[48:51], v[244:247]
    s_waitcnt vmcnt(12)
    v_mfma_f32_16x16x32_bf16 v[240:243], v[144:147], v[52:55], v[240:243]
    v_mfma_f32_16x16x32_bf16 v[244:247], v[148:151], v[52:55], v[244:247]
    s_waitcnt vmcnt(9)
    v_mfma_f32_16x16x32_bf16 v[240:243], v[152:155], v[56:59], v[240:243]
    v_mfma_f32_16x16x32_bf16 v[244:247], v[156:159], v[56:59], v[244:247]
    s_waitcnt vmcnt(6)
    v_mfma_f32_16x16x32_bf16 v[240:243], v[160:163], v[60:63], v[240:243]
    v_mfma_f32_16x16x32_bf16 v[244:247], v[164:167], v[60:63], v[244:247]
    s_waitcnt vmcnt(3)
    v_mfma_f32_16x16x32_bf16 v[240:243], v[168:171], v[64:67], v[240:243]
    v_mfma_f32_16x16x32_bf16 v[244:247], v[172:175], v[64:67], v[244:247]
    s_waitcnt vmcnt(0)
    v_mfma_f32_16x16x32_bf16 v[240:243], v[176:179], v[68:71], v[240:243]
    v_mfma_f32_16x16x32_bf16 v[244:247], v[180:183], v[68:71], v[244:247]
    s_mul_i32 s48, s45, 7168
    s_add_u32 s48, s48, 72810496
    s_mov_b32 s32, s31
    v_mov_b32 v184, 73285568
H_f1_light:
    buffer_load_dword v6, v184, s[16:19], 0 offen sc1
    s_waitcnt vmcnt(0)
    v_cmp_le_u32 vcc, s45, v6
    s_cbranch_vccnz H_f1_lgo
    s_sleep 2
    s_sub_u32 s32, s32, 1
    s_cmp_lg_u32 s32, 0
    s_cbranch_scc1 H_f1_light
    s_mov_b32 s31, 1
H_f1_lgo:
    s_mov_b32 s32, s31
    s_add_u32 s44, s48, 4096
mp_5:
    buffer_load_dwordx4 v[72:75], v4, s[16:19], s48 offen offset:0 sc1
    buffer_load_dwordx4 v[76:79], v4, s[16:19], s48 offen offset:1024 sc1
    buffer_load_dwordx4 v[80:83], v4, s[16:19], s48 offen offset:2048 sc1
    buffer_load_dwordx4 v[84:87], v4, s[16:19], s48 offen offset:3072 sc1
    buffer_load_dwordx4 v[88:91], v4, s[16:19], s44 offen offset:0 sc1
    buffer_load_dwordx4 v[92:95], v4, s[16:19], s44 offen offset:1024 sc1
    buffer_load_dwordx4 v[96:99], v4, s[16:19], s44 offen offset:2048 sc1
    s_waitcnt vmcnt(0)
    v_max3_u32 v6, v72, v73, v74
    v_max3_u32 v6, v6, v75, v76
    v_max3_u32 v6, v6, v77, v78
    v_max3_u32 v6, v6, v79, v80
    v_max3_u32 v6, v6, v81, v82
    v_max3_u32 v6, v6, v83, v84
    v_max3_u32 v6, v6, v85, v86
    v_max3_u32 v6, v6, v87, v88
    v_max3_u32 v6, v6, v89, v90
    v_max3_u32 v6, v6, v91, v92
    v_max3_u32 v6, v6, v93, v94
    v_max3_u32 v6, v6, v95, v96
    v_max3_u32 v6, v6, v97, v98
    v_max_u32 v6, v6, v99
    v_cmp_eq_u32 vcc, -1, v6
    s_cbranch_vccz mpd_6
    s_sleep 1
    s_sub_u32 s32, s32, 1
    s_cmp_lg_u32 s32, 0
    s_cbranch_scc1 mp_5
    s_mov_b32 s31, 1
mpd_6:
    ds_write_b128 v253, v[72:75] offset:0
    ds_write_b128 v253, v[76:79] offset:1024
    ds_write_b128 v253, v[80:83] offset:2048
    ds_write_b128 v253, v[84:87] offset:3072
    ds_write_b128 v253, v[88:91] offset:4096
    ds_write_b128 v253, v[92:95] offset:5120
    ds_write_b128 v253, v[96:99] offset:6144
    v_mov_b32 v6, v254
    ds_read2_b32 v[184:185], v6 offset0:0 offset1:4
    ds_read2_b32 v[186:187], v6 offset0:1 offset1:5
    ds_read2_b32 v[188:189], v6 offset0:128 offset1:132
    ds_read2_b32 v[190:191], v6 offset0:129 offset1:133
    v_add_u32 v6, 1024, v6
    ds_read2_b32 v[192:193], v6 offset0:0 offset1:4
    ds_read2_b32 v[194:195], v6 offset0:1 offset1:5
    ds_read2_b32 v[196:197], v6 offset0:128 offset1:132
    ds_read2_b32 v[198:199], v6 offset0:129 offset1:133
    v_add_u32 v6, 1024, v6
    ds_read2_b32 v[200:201], v6 offset0:0 offset1:4
    ds_read2_b32 v[202:203], v6 offset0:1 offset1:5
    ds_read2_b32 v[204:205], v6 offset0:128 offset1:132
    ds_read2_b32 v[206:207], v6 offset0:129 offset1:133
    v_add_u32 v6, 1024, v6
    ds_read2_b32 v[208:209], v6 offset0:0 offset1:4
    ds_read2_b32 v[210:211], v6 offset0:1 offset1:5
    s_waitcnt lgkmcnt(0)
    ds_read2_b32 v[212:213], v6 offset0:128 offset1:132
    ds_read2_b32 v[214:215], v6 offset0:129 offset1:133
    v_add_u32 v6, 1024, v6
    ds_read2_b32 v[216:217], v6 offset0:0 offset1:4
    ds_read2_b32 v[218:219], v6 offset0:1 offset1:5
    ds_read2_b32 v[220:221], v6 offset0:128 offset1:132
    ds_read2_b32 v[222:223], v6 offset0:129 offset1:133
    v_add_u32 v6, 1024, v6
    ds_read2_b32 v[224:225], v6 offset0:0 offset1:4
    ds_read2_b32 v[226:227], v6 offset0:1 offset1:5
    ds_read2_b32 v[228:229], v6 offset0:128 offset1:132
    ds_read2_b32 v[230:231], v6 offset0:129 offset1:133
    v_add_u32 v6, 1024, v6
    ds_read2_b32 v[232:233], v6 offset0:0 offset1:4
    ds_read2_b32 v[234:235], v6 offset0:1 offset1:5
    ds_read2_b32 v[236:237], v6 offset0:128 offset1:132
    ds_read2_b32 v[238:239], v6 offset0:129 offset1:133
    v_add_u32 v6, 1024, v6
    v_mfma_f32_16x16x32_bf16 v[248:251], v[184:187], v[16:19], 0
    v_mfma_f32_16x16x32_bf16 v[248:251], v[188:191], v[20:23], v[248:251]
    v_mfma_f32_16x16x32_bf16 v[248:251], v[192:195], v[24:27], v[248:251]
    v_mfma_f32_16x16x32_bf16 v[248:251], v[196:199], v[28:31], v[248:251]
    v_mfma_f32_16x16x32_bf16 v[248:251], v[200:203], v[32:35], v[248:251]
    v_mfma_f32_16x16x32_bf16 v[248:251], v[204:207], v[36:39], v[248:251]
    v_mfma_f32_16x16x32_bf16 v[248:251], v[208:211], v[40:43], v[248:251]
    s_waitcnt lgkmcnt(12)
    v_mfma_f32_16x16x32_bf16 v[248:251], v[212:215], v[44:47], v[248:251]
    s_waitcnt lgkmcnt(10)
    v_mfma_f32_16x16x32_bf16 v[248:251], v[216:219], v[48:51], v[248:251]
    s_waitcnt lgkmcnt(8)
    v_mfma_f32_16x16x32_bf16 v[248:251], v[220:223], v[52:55], v[248:251]
    s_waitcnt lgkmcnt(6)
    v_mfma_f32_16x16x32_bf16 v[248:251], v[224:227], v[56:59], v[248:251]
    s_waitcnt lgkmcnt(4)
    v_mfma_f32_16x16x32_bf16 v[248:251], v[228:231], v[60:63], v[248:251]
    s_waitcnt lgkmcnt(2)
    v_mfma_f32_16x16x32_bf16 v[248:251], v[232:235], v[64:67], v[248:251]
    s_waitcnt lgkmcnt(0)
    v_mfma_f32_16x16x32_bf16 v[248:251], v[236:239], v[68:71], v[248:251]
    s_lshl_b32 s41, s45, 1
    s_add_u32 s41, s41, s47
    s_mul_i32 s41, s41, 24576
    s_add_u32 s41, s41, 91914240
    s_lshl_b32 s42, s34, 10
    s_add_u32 s42, s42, s41
    s_lshr_b32 s43, s34, 1
    s_lshl_b32 s43, s43, 10
    s_add_u32 s43, s43, s41
    s_add_u32 s43, s43, 16384
    v_max3_f32 v72, v240, v241, v242
    v_max3_f32 v72, v72, v243, v244
    v_max3_f32 v72, v72, v245, v246
    v_max3_f32 v72, v72, v247, v248
    v_max_f32 v72, v72, v250
    v_mov_b32 v73, v72
    s_nop 1
    v_permlane16_swap_b32 v72, v73
    v_max_f32 v72, v72, v73
    v_mov_b32 v73, v72
    s_nop 1
    v_permlane32_swap_b32 v72, v73
    v_max_f32 v72, v72, v73
    v_sub_f32 v240, v240, v72
    v_sub_f32 v241, v241, v72
    v_sub_f32 v242, v242, v72
    v_sub_f32 v243, v243, v72
    v_sub_f32 v244, v244, v72
    v_sub_f32 v245, v245, v72
    v_sub_f32 v246, v246, v72
    v_sub_f32 v247, v247, v72
    v_sub_f32 v248, v248, v72
    v_sub_f32 v250, v250, v72
    v_exp_f32 v240, v240
    v_exp_f32 v241, v241
    v_exp_f32 v242, v242
    v_exp_f32 v243, v243
    v_exp_f32 v244, v244
    v_exp_f32 v245, v245
    v_exp_f32 v246, v246
    v_exp_f32 v247, v247
    v_exp_f32 v248, v248
    v_exp_f32 v250, v250
    v_add_f32 v72, v240, v241
    v_add_f32 v72, v72, v242
    v_add_f32 v72, v72, v243
    v_add_f32 v72, v72, v244
    v_add_f32 v72, v72, v245
    v_add_f32 v72, v72, v246
    v_add_f32 v72, v72, v247
    v_add_f32 v72, v72, v248
    v_add_f32 v72, v72, v250
    v_mov_b32 v73, v72
    s_nop 1
    v_permlane16_swap_b32 v72, v73
    v_add_f32 v72, v72, v73
    v_mov_b32 v73, v72
    s_nop 1
    v_permlane32_swap_b32 v72, v73
    v_add_f32 v72, v72, v73
    v_rcp_f32 v72, v72
    s_nop 0
    v_mul_f32 v240, v240, v72
    v_mul_f32 v241, v241, v72
    v_mul_f32 v242, v242, v72
    v_mul_f32 v243, v243, v72
    v_mul_f32 v244, v244, v72
    v_mul_f32 v245, v245, v72
    v_mul_f32 v246, v246, v72
    v_mul_f32 v247, v247, v72
    v_mul_f32 v248, v248, v72
    v_mul_f32 v250, v250, v72
    v_cvt_pk_bf16_f32 v76, v240, v241
    v_cvt_pk_bf16_f32 v77, v242, v243
    v_cvt_pk_bf16_f32 v78, v244, v245
    v_cvt_pk_bf16_f32 v79, v246, v247
    v_cvt_pk_bf16_f32 v80, v248, v248
    v_cvt_pk_bf16_f32 v81, v250, v250
    buffer_store_dwordx4 v[76:79], v4, s[16:19], s42 offen sc1
    buffer_store_dwordx2 v[80:81], v255, s[16:19], s43 offen sc1
    s_add_u32 s46, s46, 1
    v_mov_b32 v6, s46
    s_waitcnt vmcnt(0)
    s_mov_b64 exec, 1
    buffer_store_dword v6, v7, s[16:19], s37 offen sc1
    s_mov_b64 exec, -1
    s_add_u32 s45, s45, 14
    s_cmp_lt_u32 s45, 64
    s_cbranch_scc1 H_f1_step
    s_waitcnt vmcnt(0)
    s_endpgm
H_vp:
    s_mov_b32 s33, 0
    s_mov_b32 s45, 72810496
    s_mov_b32 s47, 72814592
    s_lshl_b32 s46, s36, 10
    s_add_u32 s46, s46, 77234176
    v_mov_b32 v7, 16
    v_mov_b32 v9, 73285568
    buffer_load_dwordx4 v[32:35], v4, s[16:19], s45 offen offset:0 sc1
    buffer_load_dwordx4 v[36:39], v4, s[16:19], s45 offen offset:1024 sc1
    buffer_load_dwordx4 v[40:43], v4, s[16:19], s45 offen offset:2048 sc1
    buffer_load_dwordx4 v[44:47], v4, s[16:19], s45 offen offset:3072 sc1
    buffer_load_dwordx4 v[48:51], v4, s[16:19], s47 offen offset:0 sc1
    buffer_load_dwordx4 v[52:55], v4, s[16:19], s47 offen offset:1024 sc1
    buffer_load_dwordx4 v[56:59], v4, s[16:19], s47 offen offset:2048 sc1
    s_waitcnt vmcnt(0)
H_vp_step:
    s_mov_b32 s48, s45
    s_mov_b32 s49, s47
    s_cmp_lt_u32 s33, 63
    s_cselect_b32 s41, 7168, 0
    s_add_u32 s45, s45, s41
    s_add_u32 s47, s47, s41
    buffer_load_dwordx4 v[64:67], v4, s[16:19], s45 offen offset:0 sc1
    buffer_load_dwordx4 v[68:71], v4, s[16:19], s45 offen offset:1024 sc1
    buffer_load_dwordx4 v[72:75], v4, s[16:19], s45 offen offset:2048 sc1
    buffer_load_dwordx4 v[76:79], v4, s[16:19], s45 offen offset:3072 sc1
    buffer_load_dwordx4 v[80:83], v4, s[16:19], s47 offen offset:0 sc1
    buffer_load_dwordx4 v[84:87], v4, s[16:19], s47 offen offset:1024 sc1
    buffer_load_dwordx4 v[88:91], v4, s[16:19], s47 offen offset:2048 sc1
    v_mov_b32 v96, 0
    v_mov_b32 v97, 0
    v_mov_b32 v98, 0
    v_mov_b32 v99, 0
    v_mov_b32 v100, 0
    v_mov_b32 v101, 0
    v_mov_b32 v102, 0
    v_mov_b32 v103, 0
    s_sub_u32 s41, s33, 1
    s_max_i32 s41, s41, 0
    s_waitcnt vmcnt(9)
    v_mov_b32 v8, s41
    s_mov_b64 exec, 1
    buffer_store_dword v8, v7, s[16:19], s37 offen sc1
    s_mov_b64 exec, -1
    v_max3_u32 v6, v32, v33, v34
    v_max3_u32 v6, v6, v35, v36
    v_max3_u32 v6, v6, v37, v38
    v_max3_u32 v6, v6, v39, v40
    v_max3_u32 v6, v6, v41, v42
    v_max3_u32 v6, v6, v43, v44
    v_max3_u32 v6, v6, v45, v46
    v_max3_u32 v6, v6, v47, v48
    v_max3_u32 v6, v6, v49, v50
    v_max3_u32 v6, v6, v51, v52
    v_max3_u32 v6, v6, v53, v54
    v_max3_u32 v6, v6, v55, v56
    v_max3_u32 v6, v6, v57, v58
    v_max_u32 v6, v6, v59
    v_cmp_eq_u32 vcc, -1, v6
    s_cbranch_vccz H_vp_go0
    s_waitcnt vmcnt(0)
    v_mov_b32 v8, s33
    s_mov_b64 exec, 1
    buffer_store_dword v8, v7, s[16:19], s37 offen sc1
    s_mov_b64 exec, -1
    s_mov_b32 s32, s31
H_vp_l0:
    buffer_load_dword v6, v9, s[16:19], 0 offen sc1
    s_waitcnt vmcnt(0)
    v_cmp_le_u32 vcc, s33, v6
    s_cbranch_vccnz H_vp_lg0
    s_sleep 2
    s_sub_u32 s32, s32, 1
    s_cmp_lg_u32 s32, 0
    s_cbranch_scc1 H_vp_l0
    s_mov_b32 s31, 1
H_vp_lg0:
    s_mov_b32 s32, s31
H_vp_poll0:
    buffer_load_dwordx4 v[32:35], v4, s[16:19], s48 offen offset:0 sc1
    buffer_load_dwordx4 v[36:39], v4, s[16:19], s48 offen offset:1024 sc1
    buffer_load_dwordx4 v[40:43], v4, s[16:19], s48 offen offset:2048 sc1
    buffer_load_dwordx4 v[44:47], v4, s[16:19], s48 offen offset:3072 sc1
    buffer_load_dwordx4 v[48:51], v4, s[16:19], s49 offen offset:0 sc1
    buffer_load_dwordx4 v[52:55], v4, s[16:19], s49 offen offset:1024 sc1
    buffer_load_dwordx4 v[56:59], v4, s[16:19], s49 offen offset:2048 sc1
    s_waitcnt vmcnt(0)
    v_max3_u32 v6, v32, v33, v34
    v_max3_u32 v6, v6, v35, v36
    v_max3_u32 v6, v6, v37, v38
    v_max3_u32 v6, v6, v39, v40
    v_max3_u32 v6, v6, v41, v42
    v_max3_u32 v6, v6, v43, v44
    v_max3_u32 v6, v6, v45, v46
    v_max3_u32 v6, v6, v47, v48
    v_max3_u32 v6, v6, v49, v50
    v_max3_u32 v6, v6, v51, v52
    v_max3_u32 v6, v6, v53, v54
    v_max3_u32 v6, v6, v55, v56
    v_max3_u32 v6, v6, v57, v58
    v_max_u32 v6, v6, v59
    v_cmp_eq_u32 vcc, -1, v6
    s_cbranch_vccz H_vp_go0
    s_sleep 1
    s_sub_u32 s32, s32, 1
    s_cmp_lg_u32 s32, 0
    s_cbranch_scc1 H_vp_poll0
    s_mov_b32 s31, 1
H_vp_go0:
    v_smfmac_f32_16x16x64_bf16 v[96:99], v[32:35], a[0:7], v5
    v_smfmac_f32_16x16x64_bf16 v[100:103], v[32:35], a[56:63], v5
    v_smfmac_f32_16x16x64_bf16 v[96:99], v[36:39], a[8:15], v5
    v_smfmac_f32_16x16x64_bf16 v[100:103], v[36:39], a[64:71], v5
    v_smfmac_f32_16x16x64_bf16 v[96:99], v[40:43], a[16:23], v5
    v_smfmac_f32_16x16x64_bf16 v[100:103], v[40:43], a[72:79], v5
    v_smfmac_f32_16x16x64_bf16 v[96:99], v[44:47], a[24:31], v5
    v_smfmac_f32_16x16x64_bf16 v[100:103], v[44:47], a[80:87], v5
    v_smfmac_f32_16x16x64_bf16 v[96:99], v[48:51], a[32:39], v5
    v_smfmac_f32_16x16x64_bf16 v[100:103], v[48:51], a[88:95], v5
    v_smfmac_f32_16x16x64_bf16 v[96:99], v[52:55], a[40:47], v5
    v_smfmac_f32_16x16x64_bf16 v[100:103], v[52:55], a[96:103], v5
    v_smfmac_f32_16x16x64_bf16 v[96:99], v[56:59], a[48:55], v5
    v_smfmac_f32_16x16x64_bf16 v[100:103], v[56:59], a[104:111], v5
    s_add_u32 s33, s33, 1
    s_nop 4
    v_cvt_pk_bf16_f32 v104, v96, v97
    v_cvt_pk_bf16_f32 v105, v98, v99
    v_cvt_pk_bf16_f32 v106, v100, v101
    v_cvt_pk_bf16_f32 v107, v102, v103
    buffer_store_dwordx4 v[104:107], v4, s[16:19], s46 offen sc1
    s_add_u32 s46, s46, 229376
    s_mov_b32 s48, s45
    s_mov_b32 s49, s47
    s_cmp_lt_u32 s33, 63
    s_cselect_b32 s41, 7168, 0
    s_add_u32 s45, s45, s41
    s_add_u32 s47, s47, s41
    buffer_load_dwordx4 v[32:35], v4, s[16:19], s45 offen offset:0 sc1
    buffer_load_dwordx4 v[36:39], v4, s[16:19], s45 offen offset:1024 sc1
    buffer_load_dwordx4 v[40:43], v4, s[16:19], s45 offen offset:2048 sc1
    buffer_load_dwordx4 v[44:47], v4, s[16:19], s45 offen offset:3072 sc1
    buffer_load_dwordx4 v[48:51], v4, s[16:19], s47 offen offset:0 sc1
    buffer_load_dwordx4 v[52:55], v4, s[16:19], s47 offen offset:1024 sc1
    buffer_load_dwordx4 v[56:59], v4, s[16:19], s47 offen offset:2048 sc1
    v_mov_b32 v96, 0
    v_mov_b32 v97, 0
    v_mov_b32 v98, 0
    v_mov_b32 v99, 0
    v_mov_b32 v100, 0
    v_mov_b32 v101, 0
    v_mov_b32 v102, 0
    v_mov_b32 v103, 0
    s_sub_u32 s41, s33, 1
    s_max_i32 s41, s41, 0
    s_waitcnt vmcnt(9)
    v_mov_b32 v8, s41
    s_mov_b64 exec, 1
    buffer_store_dword v8, v7, s[16:19], s37 offen sc1
    s_mov_b64 exec, -1
    v_max3_u32 v6, v64, v65, v66
    v_max3_u32 v6, v6, v67, v68
    v_max3_u32 v6, v6, v69, v70
    v_max3_u32 v6, v6, v71, v72
    v_max3_u32 v6, v6, v73, v74
    v_max3_u32 v6, v6, v75, v76
    v_max3_u32 v6, v6, v77, v78
    v_max3_u32 v6, v6, v79, v80
    v_max3_u32 v6, v6, v81, v82
    v_max3_u32 v6, v6, v83, v84
    v_max3_u32 v6, v6, v85, v86
    v_max3_u32 v6, v6, v87, v88
    v_max3_u32 v6, v6, v89, v90
    v_max_u32 v6, v6, v91
    v_cmp_eq_u32 vcc, -1, v6
    s_cbranch_vccz H_vp_go1
    s_waitcnt vmcnt(0)
    v_mov_b32 v8, s33
    s_mov_b64 exec, 1
    buffer_store_dword v8, v7, s[16:19], s37 offen sc1
    s_mov_b64 exec, -1
    s_mov_b32 s32, s31
H_vp_l1:
    buffer_load_dword v6, v9, s[16:19], 0 offen sc1
    s_waitcnt vmcnt(0)
    v_cmp_le_u32 vcc, s33, v6
    s_cbranch_vccnz H_vp_lg1
    s_sleep 2
    s_sub_u32 s32, s32, 1
    s_cmp_lg_u32 s32, 0
    s_cbranch_scc1 H_vp_l1
    s_mov_b32 s31, 1
H_vp_lg1:
    s_mov_b32 s32, s31
H_vp_poll1:
    buffer_load_dwordx4 v[64:67], v4, s[16:19], s48 offen offset:0 sc1
    buffer_load_dwordx4 v[68:71], v4, s[16:19], s48 offen offset:1024 sc1
    buffer_load_dwordx4 v[72:75], v4, s[16:19], s48 offen offset:2048 sc1
    buffer_load_dwordx4 v[76:79], v4, s[16:19], s48 offen offset:3072 sc1
    buffer_load_dwordx4 v[80:83], v4, s[16:19], s49 offen offset:0 sc1
    buffer_load_dwordx4 v[84:87], v4, s[16:19], s49 offen offset:1024 sc1
    buffer_load_dwordx4 v[88:91], v4, s[16:19], s49 offen offset:2048 sc1
    s_waitcnt vmcnt(0)
    v_max3_u32 v6, v64, v65, v66
    v_max3_u32 v6, v6, v67, v68
    v_max3_u32 v6, v6, v69, v70
    v_max3_u32 v6, v6, v71, v72
    v_max3_u32 v6, v6, v73, v74
    v_max3_u32 v6, v6, v75, v76
    v_max3_u32 v6, v6, v77, v78
    v_max3_u32 v6, v6, v79, v80
    v_max3_u32 v6, v6, v81, v82
    v_max3_u32 v6, v6, v83, v84
    v_max3_u32 v6, v6, v85, v86
    v_max3_u32 v6, v6, v87, v88
    v_max3_u32 v6, v6, v89, v90
    v_max_u32 v6, v6, v91
    v_cmp_eq_u32 vcc, -1, v6
    s_cbranch_vccz H_vp_go1
    s_sleep 1
    s_sub_u32 s32, s32, 1
    s_cmp_lg_u32 s32, 0
    s_cbranch_scc1 H_vp_poll1
    s_mov_b32 s31, 1
H_vp_go1:
    v_smfmac_f32_16x16x64_bf16 v[96:99], v[64:67], a[0:7], v5
    v_smfmac_f32_16x16x64_bf16 v[100:103], v[64:67], a[56:63], v5
    v_smfmac_f32_16x16x64_bf16 v[96:99], v[68:71], a[8:15], v5
    v_smfmac_f32_16x16x64_bf16 v[100:103], v[68:71], a[64:71], v5
    v_smfmac_f32_16x16x64_bf16 v[96:99], v[72:75], a[16:23], v5
    v_smfmac_f32_16x16x64_bf16 v[100:103], v[72:75], a[72:79], v5
    v_smfmac_f32_16x16x64_bf16 v[96:99], v[76:79], a[24:31], v5
    v_smfmac_f32_16x16x64_bf16 v[100:103], v[76:79], a[80:87], v5
    v_smfmac_f32_16x16x64_bf16 v[96:99], v[80:83], a[32:39], v5
    v_smfmac_f32_16x16x64_bf16 v[100:103], v[80:83], a[88:95], v5
    v_smfmac_f32_16x16x64_bf16 v[96:99], v[84:87], a[40:47], v5
    v_smfmac_f32_16x16x64_bf16 v[100:103], v[84:87], a[96:103], v5
    v_smfmac_f32_16x16x64_bf16 v[96:99], v[88:91], a[48:55], v5
    v_smfmac_f32_16x16x64_bf16 v[100:103], v[88:91], a[104:111], v5
    s_add_u32 s33, s33, 1
    s_nop 4
    v_cvt_pk_bf16_f32 v104, v96, v97
    v_cvt_pk_bf16_f32 v105, v98, v99
    v_cvt_pk_bf16_f32 v106, v100, v101
    v_cvt_pk_bf16_f32 v107, v102, v103
    buffer_store_dwordx4 v[104:107], v4, s[16:19], s46 offen sc1
    s_add_u32 s46, s46, 229376
    s_cmp_lt_u32 s33, 64
    s_cbranch_scc1 H_vp_step
    s_waitcnt vmcnt(0)
    v_mov_b32 v8, s33
    s_mov_b64 exec, 1
    buffer_store_dword v8, v7, s[16:19], s37 offen sc1
    s_mov_b64 exec, -1
    s_waitcnt vmcnt(0)
    s_endpgm
H_f2:
    s_mov_b32 s52, s8
    s_mov_b32 s53, s9
    s_mov_b32 s54, 1835008
    s_mov_b32 s55, 0x20000
    v_mov_b32 v8, 73269276
    v_mov_b32 v10, 0
    s_mov_b32 s32, s31
fw_7:
    buffer_load_dword v11, v8, s[16:19], 0 offen sc1
    s_waitcnt vmcnt(0)
    v_cmp_lt_u32 vcc, v10, v11
    s_nop 0
    s_cmp_eq_u64 vcc, -1
    s_cbranch_scc1 fgo_8
    s_sleep 8
    s_sub_u32 s32, s32, 1
    s_cmp_lg_u32 s32, 0
    s_cbranch_scc1 fw_7
    s_mov_b32 s31, 1
fgo_8:
    v_mov_b32 v8, 73269280
    buffer_load_dwordx2 v[14:15], v8, s[16:19], 0 offen sc1
    s_and_b32 s47, s34, 1
    s_lshr_b32 s46, s34, 1
    s_mov_b32 s45, 0
    v_mul_u32_u24 v8, 896, v3
    v_add_u32 v8, 73269248, v8
    v_mul_u32_u24 v12, 896, v3
    v_lshl_add_u32 v12, v2, 4, v12
    s_waitcnt vmcnt(0)
    v_readfirstlane_b32 s49, v14
    v_cvt_pk_bf16_f32 v15, v15, v15
    v_and_b32 v15, 0xffff0000, v15
    v_mul_f32 v15, 0xbfb8aa3b, v15
    v_exp_f32 v15, v15
    s_nop 0
    v_add_f32 v15, 1.0, v15
    v_rcp_f32 v15, v15
    s_nop 0
    v_cvt_pk_bf16_f32 v15, v15, v15
    v_and_b32 v15, 0xffff0000, v15
    s_nop 0
    v_readfirstlane_b32 s50, v15
H_f2_step:
    s_lshl_b32 s48, s46, 1
    s_add_u32 s48, s48, s47
    s_lshl_b32 s41, s35, 6
    s_and_b32 s42, s46, 3
    s_lshl_b32 s42, s42, 2
    s_add_u32 s42, s42, s41
    v_add_u32 v9, s42, v8
    s_lshr_b32 s42, s46, 2
    v_mov_b32 v10, s42
    s_mov_b32 s32, s31
fw_9:
    buffer_load_dword v11, v9, s[16:19], 0 offen sc1
    s_waitcnt vmcnt(0)
    v_cmp_lt_u32 vcc, v10, v11
    s_nop 0
    s_cmp_eq_u64 vcc, -1
    s_cbranch_scc1 fgo_10
    s_sleep 8
    s_sub_u32 s32, s32, 1
    s_cmp_lg_u32 s32, 0
    s_cbranch_scc1 fw_9
    s_mov_b32 s31, 1
fgo_10:
    s_mul_i32 s41, s46, 458752
    s_lshl_b32 s42, s35, 11
    s_add_u32 s41, s41, s42
    s_add_u32 s41, s41, 12845056
    buffer_load_dwordx4 a[0:3], v4, s[16:19], s41 offen offset:0 sc1
    buffer_load_dwordx4 a[4:7], v4, s[16:19], s41 offen offset:1024 sc1
    s_add_u32 s41, s41, 28672
    buffer_load_dwordx4 a[8:11], v4, s[16:19], s41 offen offset:0 sc1
    buffer_load_dwordx4 a[12:15], v4, s[16:19], s41 offen offset:1024 sc1
    s_add_u32 s41, s41, 28672
    buffer_load_dwordx4 a[16:19], v4, s[16:19], s41 offen offset:0 sc1
    buffer_load_dwordx4 a[20:23], v4, s[16:19], s41 offen offset:1024 sc1
    s_add_u32 s41, s41, 28672
    buffer_load_dwordx4 a[24:27], v4, s[16:19], s41 offen offset:0 sc1
    buffer_load_dwordx4 a[28:31], v4, s[16:19], s41 offen offset:1024 sc1
    s_add_u32 s41, s41, 28672
    buffer_load_dwordx4 a[32:35], v4, s[16:19], s41 offen offset:0 sc1
    buffer_load_dwordx4 a[36:39], v4, s[16:19], s41 offen offset:1024 sc1
    s_add_u32 s41, s41, 28672
    buffer_load_dwordx4 a[40:43], v4, s[16:19], s41 offen offset:0 sc1
    buffer_load_dwordx4 a[44:47], v4, s[16:19], s41 offen offset:1024 sc1
    s_add_u32 s41, s41, 28672
    buffer_load_dwordx4 a[48:51], v4, s[16:19], s41 offen offset:0 sc1
    buffer_load_dwordx4 a[52:55], v4, s[16:19], s41 offen offset:1024 sc1
    s_add_u32 s41, s41, 28672
    buffer_load_dwordx4 a[56:59], v4, s[16:19], s41 offen offset:0 sc1
    buffer_load_dwordx4 a[60:63], v4, s[16:19], s41 offen offset:1024 sc1
    s_add_u32 s41, s41, 28672
    buffer_load_dwordx4 a[64:67], v4, s[16:19], s41 offen offset:0 sc1
    buffer_load_dwordx4 a[68:71], v4, s[16:19], s41 offen offset:1024 sc1
    s_add_u32 s41, s41, 28672
    buffer_load_dwordx4 a[72:75], v4, s[16:19], s41 offen offset:0 sc1
    buffer_load_dwordx4 a[76:79], v4, s[16:19], s41 offen offset:1024 sc1
    s_add_u32 s41, s41, 28672
    buffer_load_dwordx4 a[80:83], v4, s[16:19], s41 offen offset:0 sc1
    buffer_load_dwordx4 a[84:87], v4, s[16:19], s41 offen offset:1024 sc1
    s_add_u32 s41, s41, 28672
    buffer_load_dwordx4 a[88:91], v4, s[16:19], s41 offen offset:0 sc1
    buffer_load_dwordx4 a[92:95], v4, s[16:19], s41 offen offset:1024 sc1
    s_add_u32 s41, s41, 28672
    buffer_load_dwordx4 a[96:99], v4, s[16:19], s41 offen offset:0 sc1
    buffer_load_dwordx4 a[100:103], v4, s[16:19], s41 offen offset:1024 sc1
    s_add_u32 s41, s41, 28672
    buffer_load_dwordx4 a[104:107], v4, s[16:19], s41 offen offset:0 sc1
    buffer_load_dwordx4 a[108:111], v4, s[16:19], s41 offen offset:1024 sc1
    s_add_u32 s41, s41, 28672
    buffer_load_dwordx4 a[112:115], v4, s[16:19], s41 offen offset:0 sc1
    buffer_load_dwordx4 a[116:119], v4, s[16:19], s41 offen offset:1024 sc1
    s_add_u32 s41, s41, 28672
    buffer_load_dwordx4 a[120:123], v4, s[16:19], s41 offen offset:0 sc1
    buffer_load_dwordx4 a[124:127], v4, s[16:19], s41 offen offset:1024 sc1
    s_add_u32 s41, s41, 28672
    s_mul_i32 s41, s48, 14
    s_add_u32 s41, s41, s35
    s_lshl_b32 s41, s41, 10
    s_add_u32 s41, s41, 75382784
    buffer_load_dwordx4 v[184:187], v4, s[16:19], s41 offen sc1
    s_lshl_b32 s41, s48, 6
    s_add_u32 s41, s41, 77225984
    v_lshlrev_b32 v13, 2, v3
    buffer_load_dword v188, v13, s[16:19], s41 offen sc1
    s_mul_i32 s42, s46, 4682
    s_lshr_b32 s42, s42, 16
    s_mul_i32 s43, s42, 14
    s_sub_u32 s43, s46, s43
    s_lshl_b32 s43, s43, 6
    s_lshl_b32 s44, s47, 2
    s_add_u32 s43, s43, s44
    s_add_u32 s43, s43, 20
    s_lshl_b32 s41, s35, 6
    s_add_u32 s41, s41, 16
    v_mov_b32 v13, s41
    v_mov_b32 v14, s43
    v_mov_b32 v15, s46
    v_mov_b32 v10, s42
    v_cmp_gt_u32 vcc, 16, v1
    s_nop 1
    v_cndmask_b32 v13, v14, v13, vcc
    v_cndmask_b32 v10, v10, v15, vcc
    v_add_u32 v9, v13, v8
    v_mov_b32 v13, 73285568
    s_mov_b32 s32, s31
H_f2_l:
    buffer_load_dword v14, v13, s[16:19], 0 offen sc1
    s_waitcnt vmcnt(0)
    v_cmp_le_u32 vcc, s46, v14
    s_cbranch_vccnz H_f2_lg
    s_sleep 8
    s_sub_u32 s32, s32, 1
    s_cmp_lg_u32 s32, 0
    s_cbranch_scc1 H_f2_l
    s_mov_b32 s31, 1
H_f2_lg:
    s_sleep 16
    s_mov_b64 exec, 0xffffffff
    s_mov_b32 s32, s31
fw_11:
    buffer_load_dword v11, v9, s[16:19], 0 offen sc1
    s_waitcnt vmcnt(0)
    v_cmp_lt_u32 vcc, v10, v11
    s_nop 0
    s_cmp_eq_u64 vcc, exec
    s_cbranch_scc1 fgo_12
    s_sleep 4
    s_sub_u32 s32, s32, 1
    s_cmp_lg_u32 s32, 0
    s_cbranch_scc1 fw_11
    s_mov_b32 s31, 1
fgo_12:
    s_mov_b64 exec, -1
    s_mul_i32 s41, s48, 24576
    s_add_u32 s41, s41, 91914240
    s_mul_i32 s42, s46, 229376
    s_lshl_b32 s43, s35, 10
    s_add_u32 s42, s42, s43
    s_add_u32 s42, s42, 77234176
    buffer_load_dwordx4 v[16:19], v4, s[16:19], s41 offen offset:0 sc1
    buffer_load_dwordx4 v[20:23], v4, s[16:19], s41 offen offset:1024 sc1
    buffer_load_dwordx4 v[24:27], v4, s[16:19], s41 offen offset:2048 sc1
    buffer_load_dwordx4 v[28:31], v4, s[16:19], s41 offen offset:3072 sc1
    s_add_u32 s41, s41, 4096
    buffer_load_dwordx4 v[32:35], v4, s[16:19], s41 offen offset:0 sc1
    buffer_load_dwordx4 v[36:39], v4, s[16:19], s41 offen offset:1024 sc1
    buffer_load_dwordx4 v[40:43], v4, s[16:19], s41 offen offset:2048 sc1
    buffer_load_dwordx4 v[44:47], v4, s[16:19], s41 offen offset:3072 sc1
    s_add_u32 s41, s41, 4096
    buffer_load_dwordx4 v[48:51], v4, s[16:19], s41 offen offset:0 sc1
    buffer_load_dwordx4 v[52:55], v4, s[16:19], s41 offen offset:1024 sc1
    buffer_load_dwordx4 v[56:59], v4, s[16:19], s41 offen offset:2048 sc1
    buffer_load_dwordx4 v[60:63], v4, s[16:19], s41 offen offset:3072 sc1
    s_add_u32 s41, s41, 4096
    buffer_load_dwordx4 v[64:67], v4, s[16:19], s41 offen offset:0 sc1
    buffer_load_dwordx4 v[68:71], v4, s[16:19], s41 offen offset:1024 sc1
    buffer_load_dwordx4 v[72:75], v4, s[16:19], s41 offen offset:2048 sc1
    buffer_load_dwordx4 v[76:79], v4, s[16:19], s41 offen offset:3072 sc1
    s_add_u32 s41, s41, 4096
    buffer_load_dwordx4 v[80:83], v4, s[16:19], s41 offen offset:0 sc1
    buffer_load_dwordx4 v[84:87], v4, s[16:19], s41 offen offset:1024 sc1
    buffer_load_dwordx4 v[88:91], v4, s[16:19], s41 offen offset:2048 sc1
    buffer_load_dwordx4 v[92:95], v4, s[16:19], s41 offen offset:3072 sc1
    s_add_u32 s41, s41, 4096
    buffer_load_dwordx4 v[96:99], v4, s[16:19], s41 offen offset:0 sc1
    buffer_load_dwordx4 v[100:103], v4, s[16:19], s41 offen offset:1024 sc1
    buffer_load_dwordx4 v[104:107], v4, s[16:19], s41 offen offset:2048 sc1
    buffer_load_dwordx4 v[108:111], v4, s[16:19], s41 offen offset:3072 sc1
    s_add_u32 s41, s41, 4096
    buffer_load_dwordx4 v[112:115], v4, s[16:19], s42 offen sc1
    s_add_u32 s42, s42, 14336
    buffer_load_dwordx4 v[116:119], v4, s[16:19], s42 offen sc1
    s_add_u32 s42, s42, 14336
    buffer_load_dwordx4 v[120:123], v4, s[16:19], s42 offen sc1
    s_add_u32 s42, s42, 14336
    buffer_load_dwordx4 v[124:127], v4, s[16:19], s42 offen sc1
    s_add_u32 s42, s42, 14336
    buffer_load_dwordx4 v[128:131], v4, s[16:19], s42 offen sc1
    s_add_u32 s42, s42, 14336
    buffer_load_dwordx4 v[132:135], v4, s[16:19], s42 offen sc1
    s_add_u32 s42, s42, 14336
    buffer_load_dwordx4 v[136:139], v4, s[16:19], s42 offen sc1
    s_add_u32 s42, s42, 14336
    buffer_load_dwordx4 v[140:143], v4, s[16:19], s42 offen sc1
    s_add_u32 s42, s42, 14336
    buffer_load_dwordx4 v[144:147], v4, s[16:19], s42 offen sc1
    s_add_u32 s42, s42, 14336
    buffer_load_dwordx4 v[148:151], v4, s[16:19], s42 offen sc1
    s_add_u32 s42, s42, 14336
    buffer_load_dwordx4 v[152:155], v4, s[16:19], s42 offen sc1
    s_add_u32 s42, s42, 14336
    buffer_load_dwordx4 v[156:159], v4, s[16:19], s42 offen sc1
    s_add_u32 s42, s42, 14336
    buffer_load_dwordx4 v[160:163], v4, s[16:19], s42 offen sc1
    s_add_u32 s42, s42, 14336
    buffer_load_dwordx4 v[164:167], v4, s[16:19], s42 offen sc1
    s_add_u32 s42, s42, 14336
    buffer_load_dwordx4 v[168:171], v4, s[16:19], s42 offen sc1
    s_add_u32 s42, s42, 14336
    buffer_load_dwordx4 v[172:175], v4, s[16:19], s42 offen sc1
    s_add_u32 s42, s42, 14336
    s_waitcnt vmcnt(39)
    v_mfma_f32_16x16x32_bf16 v[176:179], a[0:3], v[16:19], 0
    v_mfma_f32_16x16x32_bf16 v[180:183], a[4:7], v[16:19], 0
    s_waitcnt vmcnt(38)
    v_mfma_f32_16x16x32_bf16 v[176:179], a[8:11], v[20:23], v[176:179]
    v_mfma_f32_16x16x32_bf16 v[180:183], a[12:15], v[20:23], v[180:183]
    s_waitcnt vmcnt(37)
    v_mfma_f32_16x16x32_bf16 v[176:179], a[16:19], v[24:27], v[176:179]
    v_mfma_f32_16x16x32_bf16 v[180:183], a[20:23], v[24:27], v[180:183]
    s_waitcnt vmcnt(36)
    v_mfma_f32_16x16x32_bf16 v[176:179], a[24:27], v[28:31], v[176:179]
    v_mfma_f32_16x16x32_bf16 v[180:183], a[28:31], v[28:31], v[180:183]
    s_waitcnt vmcnt(35)
    v_mfma_f32_16x16x32_bf16 v[176:179], a[32:35], v[32:35], v[176:179]
    v_mfma_f32_16x16x32_bf16 v[180:183], a[36:39], v[32:35], v[180:183]
    s_waitcnt vmcnt(34)
    v_mfma_f32_16x16x32_bf16 v[176:179], a[40:43], v[36:39], v[176:179]
    v_mfma_f32_16x16x32_bf16 v[180:183], a[44:47], v[36:39], v[180:183]
    s_waitcnt vmcnt(33)
    v_mfma_f32_16x16x32_bf16 v[176:179], a[48:51], v[40:43], v[176:179]
    v_mfma_f32_16x16x32_bf16 v[180:183], a[52:55], v[40:43], v[180:183]
    s_waitcnt vmcnt(32)
    v_mfma_f32_16x16x32_bf16 v[176:179], a[56:59], v[44:47], v[176:179]
    v_mfma_f32_16x16x32_bf16 v[180:183], a[60:63], v[44:47], v[180:183]
    s_waitcnt vmcnt(31)
    v_mfma_f32_16x16x32_bf16 v[176:179], a[64:67], v[48:51], v[176:179]
    v_mfma_f32_16x16x32_bf16 v[180:183], a[68:71], v[48:51], v[180:183]
    s_waitcnt vmcnt(30)
    v_mfma_f32_16x16x32_bf16 v[176:179], a[72:75], v[52:55], v[176:179]
    v_mfma_f32_16x16x32_bf16 v[180:183], a[76:79], v[52:55], v[180:183]
    s_waitcnt vmcnt(29)
    v_mfma_f32_16x16x32_bf16 v[176:179], a[80:83], v[56:59], v[176:179]
    v_mfma_f32_16x16x32_bf16 v[180:183], a[84:87], v[56:59], v[180:183]
    s_waitcnt vmcnt(28)
    v_mfma_f32_16x16x32_bf16 v[176:179], a[88:91], v[60:63], v[176:179]
    v_mfma_f32_16x16x32_bf16 v[180:183], a[92:95], v[60:63], v[180:183]
    s_waitcnt vmcnt(27)
    v_mfma_f32_16x16x32_bf16 v[176:179], a[96:99], v[64:67], v[176:179]
    v_mfma_f32_16x16x32_bf16 v[180:183], a[100:103], v[64:67], v[180:183]
    s_waitcnt vmcnt(26)
    v_mfma_f32_16x16x32_bf16 v[176:179], a[104:107], v[68:71], v[176:179]
    v_mfma_f32_16x16x32_bf16 v[180:183], a[108:111], v[68:71], v[180:183]
    s_waitcnt vmcnt(25)
    v_mfma_f32_16x16x32_bf16 v[176:179], a[112:115], v[72:75], v[176:179]
    v_mfma_f32_16x16x32_bf16 v[180:183], a[116:119], v[72:75], v[180:183]
    s_waitcnt vmcnt(24)
    v_mfma_f32_16x16x32_bf16 v[176:179], a[120:123], v[76:79], v[176:179]
    v_mfma_f32_16x16x32_bf16 v[180:183], a[124:127], v[76:79], v[180:183]
    s_waitcnt vmcnt(14)
    v_swap_b32 v114, v116
    v_swap_b32 v115, v117
    s_nop 1
    v_mfma_f32_16x16x32_bf16 v[176:179], v[112:115], v[80:83], v[176:179]
    v_mfma_f32_16x16x32_bf16 v[180:183], v[116:119], v[80:83], v[180:183]
    s_waitcnt vmcnt(12)
    v_swap_b32 v122, v124
    v_swap_b32 v123, v125
    s_nop 1
    v_mfma_f32_16x16x32_bf16 v[176:179], v[120:123], v[84:87], v[176:179]
    v_mfma_f32_16x16x32_bf16 v[180:183], v[124:127], v[84:87], v[180:183]
    s_waitcnt vmcnt(10)
    v_swap_b32 v130, v132
    v_swap_b32 v131, v133
    s_nop 1
    v_mfma_f32_16x16x32_bf16 v[176:179], v[128:131], v[88:91], v[176:179]
    v_mfma_f32_16x16x32_bf16 v[180:183], v[132:135], v[88:91], v[180:183]
    s_waitcnt vmcnt(8)
    v_swap_b32 v138, v140
    v_swap_b32 v139, v141
    s_nop 1
    v_mfma_f32_16x16x32_bf16 v[176:179], v[136:139], v[92:95], v[176:179]
    v_mfma_f32_16x16x32_bf16 v[180:183], v[140:143], v[92:95], v[180:183]
    s_waitcnt vmcnt(6)
    v_swap_b32 v146, v148
    v_swap_b32 v147, v149
    s_nop 1
    v_mfma_f32_16x16x32_bf16 v[176:179], v[144:147], v[96:99], v[176:179]
    v_mfma_f32_16x16x32_bf16 v[180:183], v[148:151], v[96:99], v[180:183]
    s_waitcnt vmcnt(4)
    v_swap_b32 v154, v156
    v_swap_b32 v155, v157
    s_nop 1
    v_mfma_f32_16x16x32_bf16 v[176:179], v[152:155], v[100:103], v[176:179]
    v_mfma_f32_16x16x32_bf16 v[180:183], v[156:159], v[100:103], v[180:183]
    s_waitcnt vmcnt(2)
    v_swap_b32 v162, v164
    v_swap_b32 v163, v165
    s_nop 1
    v_mfma_f32_16x16x32_bf16 v[176:179], v[160:163], v[104:107], v[176:179]
    v_mfma_f32_16x16x32_bf16 v[180:183], v[164:167], v[104:107], v[180:183]
    s_waitcnt vmcnt(0)
    v_swap_b32 v170, v172
    v_swap_b32 v171, v173
    s_nop 1
    v_mfma_f32_16x16x32_bf16 v[176:179], v[168:171], v[108:111], v[176:179]
    v_mfma_f32_16x16x32_bf16 v[180:183], v[172:175], v[108:111], v[180:183]
    v_lshlrev_b32 v16, 16, v184
    v_and_b32 v17, 0xffff0000, v184
    v_lshlrev_b32 v18, 16, v185
    v_and_b32 v19, 0xffff0000, v185
    v_lshlrev_b32 v20, 16, v186
    v_and_b32 v21, 0xffff0000, v186
    v_lshlrev_b32 v22, 16, v187
    v_and_b32 v23, 0xffff0000, v187
    s_lshr_b32 s41, s49, 4
    s_cmp_lg_u32 s41, s48
    s_cbranch_scc1 H_f2_nomod
    v_min_u32 v13, 27, v1
    v_lshlrev_b32 v13, 6, v13
    v_add_u32 v13, 73269276, v13
    v_mov_b32 v10, 0
    s_mov_b32 s32, s31
fw_13:
    buffer_load_dword v11, v13, s[16:19], 0 offen sc1
    s_waitcnt vmcnt(0)
    v_cmp_lt_u32 vcc, v10, v11
    s_nop 0
    s_cmp_eq_u64 vcc, -1
    s_cbranch_scc1 fgo_14
    s_sleep 8
    s_sub_u32 s32, s32, 1
    s_cmp_lg_u32 s32, 0
    s_cbranch_scc1 fw_13
    s_mov_b32 s31, 1
fgo_14:
    v_lshlrev_b32 v13, 5, v2
    s_lshl_b32 s41, s35, 7
    s_add_u32 s41, s41, 95059968
    s_mov_b32 s42, 28
    v_mov_b32 v80, 0
    v_mov_b32 v81, 0
    v_mov_b32 v82, 0
    v_mov_b32 v83, 0
    v_mov_b32 v84, 0
    v_mov_b32 v85, 0
    v_mov_b32 v86, 0
    v_mov_b32 v87, 0
H_f2_ysum:
    buffer_load_dwordx4 v[88:91], v13, s[16:19], s41 offen sc1
    buffer_load_dwordx4 v[92:95], v13, s[16:19], s41 offen offset:16 sc1
    s_add_u32 s41, s41, 1792
    s_waitcnt vmcnt(0)
    v_add_f32 v80, v80, v88
    v_add_f32 v81, v81, v89
    v_add_f32 v82, v82, v90
    v_add_f32 v83, v83, v91
    v_add_f32 v84, v84, v92
    v_add_f32 v85, v85, v93
    v_add_f32 v86, v86, v94
    v_add_f32 v87, v87, v95
    s_sub_u32 s42, s42, 1
    s_cmp_lg_u32 s42, 0
    s_cbranch_scc1 H_f2_ysum
    s_and_b32 s41, s49, 15
    v_cmp_eq_u32 vcc, s41, v3
    v_cvt_pk_bf16_f32 v80, v80, v80
    v_and_b32 v80, 0xffff0000, v80
    v_mul_f32 v80, s50, v80
    v_cvt_pk_bf16_f32 v80, v80, v80
    v_and_b32 v80, 0xffff0000, v80
    v_add_f32 v80, v80, v16
    v_cvt_pk_bf16_f32 v80, v80, v80
    v_and_b32 v80, 0xffff0000, v80
    v_cndmask_b32 v16, v16, v80, vcc
    v_cvt_pk_bf16_f32 v81, v81, v81
    v_and_b32 v81, 0xffff0000, v81
    v_mul_f32 v81, s50, v81
    v_cvt_pk_bf16_f32 v81, v81, v81
    v_and_b32 v81, 0xffff0000, v81
    v_add_f32 v81, v81, v17
    v_cvt_pk_bf16_f32 v81, v81, v81
    v_and_b32 v81, 0xffff0000, v81
    v_cndmask_b32 v17, v17, v81, vcc
    v_cvt_pk_bf16_f32 v82, v82, v82
    v_and_b32 v82, 0xffff0000, v82
    v_mul_f32 v82, s50, v82
    v_cvt_pk_bf16_f32 v82, v82, v82
    v_and_b32 v82, 0xffff0000, v82
    v_add_f32 v82, v82, v18
    v_cvt_pk_bf16_f32 v82, v82, v82
    v_and_b32 v82, 0xffff0000, v82
    v_cndmask_b32 v18, v18, v82, vcc
    v_cvt_pk_bf16_f32 v83, v83, v83
    v_and_b32 v83, 0xffff0000, v83
    v_mul_f32 v83, s50, v83
    v_cvt_pk_bf16_f32 v83, v83, v83
    v_and_b32 v83, 0xffff0000, v83
    v_add_f32 v83, v83, v19
    v_cvt_pk_bf16_f32 v83, v83, v83
    v_and_b32 v83, 0xffff0000, v83
    v_cndmask_b32 v19, v19, v83, vcc
    v_cvt_pk_bf16_f32 v84, v84, v84
    v_and_b32 v84, 0xffff0000, v84
    v_mul_f32 v84, s50, v84
    v_cvt_pk_bf16_f32 v84, v84, v84
    v_and_b32 v84, 0xffff0000, v84
    v_add_f32 v84, v84, v20
    v_cvt_pk_bf16_f32 v84, v84, v84
    v_and_b32 v84, 0xffff0000, v84
    v_cndmask_b32 v20, v20, v84, vcc
    v_cvt_pk_bf16_f32 v85, v85, v85
    v_and_b32 v85, 0xffff0000, v85
    v_mul_f32 v85, s50, v85
    v_cvt_pk_bf16_f32 v85, v85, v85
    v_and_b32 v85, 0xffff0000, v85
    v_add_f32 v85, v85, v21
    v_cvt_pk_bf16_f32 v85, v85, v85
    v_and_b32 v85, 0xffff0000, v85
    v_cndmask_b32 v21, v21, v85, vcc
    v_cvt_pk_bf16_f32 v86, v86, v86
    v_and_b32 v86, 0xffff0000, v86
    v_mul_f32 v86, s50, v86
    v_cvt_pk_bf16_f32 v86, v86, v86
    v_and_b32 v86, 0xffff0000, v86
    v_add_f32 v86, v86, v22
    v_cvt_pk_bf16_f32 v86, v86, v86
    v_and_b32 v86, 0xffff0000, v86
    v_cndmask_b32 v22, v22, v86, vcc
    v_cvt_pk_bf16_f32 v87, v87, v87
    v_and_b32 v87, 0xffff0000, v87
    v_mul_f32 v87, s50, v87
    v_cvt_pk_bf16_f32 v87, v87, v87
    v_and_b32 v87, 0xffff0000, v87
    v_add_f32 v87, v87, v23
    v_cvt_pk_bf16_f32 v87, v87, v87
    v_and_b32 v87, 0xffff0000, v87
    v_cndmask_b32 v23, v23, v87, vcc
H_f2_nomod:
    v_sub_f32 v96, 1.0, v188
    v_cvt_pk_bf16_f32 v96, v96, v96
    v_and_b32 v96, 0xffff0000, v96
    v_cvt_pk_bf16_f32 v104, v176, v180
    v_lshlrev_b32 v176, 16, v104
    v_and_b32 v180, 0xffff0000, v104
    v_mul_f32 v176, v176, v188
    v_mul_f32 v180, v180, v188
    v_cvt_pk_bf16_f32 v104, v176, v180
    v_lshlrev_b32 v176, 16, v104
    v_and_b32 v180, 0xffff0000, v104
    v_mul_f32 v16, v16, v96
    v_mul_f32 v17, v17, v96
    v_cvt_pk_bf16_f32 v104, v16, v17
    v_lshlrev_b32 v16, 16, v104
    v_and_b32 v17, 0xffff0000, v104
    v_add_f32 v176, v176, v16
    v_add_f32 v180, v180, v17
    v_cvt_pk_bf16_f32 v100, v176, v180
    v_cvt_pk_bf16_f32 v104, v177, v181
    v_lshlrev_b32 v177, 16, v104
    v_and_b32 v181, 0xffff0000, v104
    v_mul_f32 v177, v177, v188
    v_mul_f32 v181, v181, v188
    v_cvt_pk_bf16_f32 v104, v177, v181
    v_lshlrev_b32 v177, 16, v104
    v_and_b32 v181, 0xffff0000, v104
    v_mul_f32 v18, v18, v96
    v_mul_f32 v19, v19, v96
    v_cvt_pk_bf16_f32 v104, v18, v19
    v_lshlrev_b32 v18, 16, v104
    v_and_b32 v19, 0xffff0000, v104
    v_add_f32 v177, v177, v18
    v_add_f32 v181, v181, v19
    v_cvt_pk_bf16_f32 v101, v177, v181
    v_cvt_pk_bf16_f32 v104, v178, v182
    v_lshlrev_b32 v178, 16, v104
    v_and_b32 v182, 0xffff0000, v104
    v_mul_f32 v178, v178, v188
    v_mul_f32 v182, v182, v188
    v_cvt_pk_bf16_f32 v104, v178, v182
    v_lshlrev_b32 v178, 16, v104
    v_and_b32 v182, 0xffff0000, v104
    v_mul_f32 v20, v20, v96
    v_mul_f32 v21, v21, v96
    v_cvt_pk_bf16_f32 v104, v20, v21
    v_lshlrev_b32 v20, 16, v104
    v_and_b32 v21, 0xffff0000, v104
    v_add_f32 v178, v178, v20
    v_add_f32 v182, v182, v21
    v_cvt_pk_bf16_f32 v102, v178, v182
    v_cvt_pk_bf16_f32 v104, v179, v183
    v_lshlrev_b32 v179, 16, v104
    v_and_b32 v183, 0xffff0000, v104
    v_mul_f32 v179, v179, v188
    v_mul_f32 v183, v183, v188
    v_cvt_pk_bf16_f32 v104, v179, v183
    v_lshlrev_b32 v179, 16, v104
    v_and_b32 v183, 0xffff0000, v104
    v_mul_f32 v22, v22, v96
    v_mul_f32 v23, v23, v96
    v_cvt_pk_bf16_f32 v104, v22, v23
    v_lshlrev_b32 v22, 16, v104
    v_and_b32 v23, 0xffff0000, v104
    v_add_f32 v179, v179, v22
    v_add_f32 v183, v183, v23
    v_cvt_pk_bf16_f32 v103, v179, v183
    s_mul_i32 s41, s48, 14336
    s_lshl_b32 s42, s35, 6
    s_add_u32 s41, s41, s42
    buffer_store_dwordx4 v[100:103], v12, s[52:55], s41 offen
    s_add_u32 s46, s46, 8
    s_add_u32 s45, s45, 1
    s_cmp_lt_u32 s45, 8
    s_cbranch_scc1 H_f2_step
    s_waitcnt vmcnt(0)
    s_endpgm
L_exit:
    s_endpgm
L_role_T:
    v_and_b32 v40, 63, v0
    v_lshrrev_b32 v41, 4, v40
    v_and_b32 v42, 15, v40
    v_and_b32 v20, 1, v0
    v_cmp_eq_u32 vcc, 0, v20
    v_mov_b32 v20, 0xEEEE
    v_mov_b32 v21, 0x4444
    v_cndmask_b32 v1, v20, v21, vcc
    s_lshl_b32 s41, s28, 1
    s_add_u32 s42, s41, 0
    s_sub_u32 s43, s42, 7
    s_cmp_ge_u32 s42, 7
    s_cselect_b32 s34, s43, s42
    s_lshl_b32 s42, s34, 10
    v_lshl_add_u32 v2, v40, 4, s42
    s_add_u32 s42, s41, 1
    s_sub_u32 s43, s42, 7
    s_cmp_ge_u32 s42, 7
    s_cselect_b32 s35, s43, s42
    s_lshl_b32 s42, s35, 10
    v_lshl_add_u32 v3, v40, 4, s42
    s_add_u32 s42, s41, 2
    s_sub_u32 s43, s42, 7
    s_cmp_ge_u32 s42, 7
    s_cselect_b32 s36, s43, s42
    s_lshl_b32 s42, s36, 10
    v_lshl_add_u32 v4, v40, 4, s42
    s_add_u32 s42, s41, 3
    s_sub_u32 s43, s42, 7
    s_cmp_ge_u32 s42, 7
    s_cselect_b32 s37, s43, s42
    s_lshl_b32 s42, s37, 10
    v_lshl_add_u32 v5, v40, 4, s42
    s_add_u32 s42, s41, 4
    s_sub_u32 s43, s42, 7
    s_cmp_ge_u32 s42, 7
    s_cselect_b32 s38, s43, s42
    s_lshl_b32 s42, s38, 10
    v_lshl_add_u32 v6, v40, 4, s42
    s_add_u32 s42, s41, 5
    s_sub_u32 s43, s42, 7
    s_cmp_ge_u32 s42, 7
    s_cselect_b32 s39, s43, s42
    s_lshl_b32 s42, s39, 10
    v_lshl_add_u32 v7, v40, 4, s42
    s_add_u32 s42, s41, 6
    s_sub_u32 s43, s42, 7
    s_cmp_ge_u32 s42, 7
    s_cselect_b32 s40, s43, s42
    s_lshl_b32 s42, s40, 10
    v_lshl_add_u32 v8, v40, 4, s42
    s_mov_b32 s31, 200000
    s_mov_b32 s33, 0
    s_mov_b32 s45, 71565312
    s_mov_b32 s46, 72024064
    s_and_b32 s80, s28, 1
    s_mul_i32 s41, s28, 7
    s_add_u32 s81, s41, s80
    s_lshr_b32 s83, s81, 1
    s_add_u32 s42, s41, 6
    s_cmp_eq_u32 s80, 1
    s_cselect_b32 s82, s41, s42
    s_lshr_b32 s84, s82, 1
    v_lshlrev_b32 v43, 4, v40
    v_sub_u32 v43, 0, v43
    s_mul_i32 s44, s29, 401408
    s_mul_i32 s42, s28, 7
    s_add_u32 s43, s42, 6
    s_lshr_b32 s42, s42, 2
    s_lshr_b32 s43, s43, 2
    s_lshl1_add_u32 s43, s43, 1
    v_lshrrev_b32 v20, 2, v40
    v_lshl_add_u32 v20, s42, 1, v20
    v_min_u32 v20, s43, v20
    s_mul_i32 s42, s29, 14
    v_add_u32 v20, s42, v20
    v_lshlrev_b32 v20, 6, v20
    v_and_b32 v21, 3, v40
    v_lshl_add_u32 v20, v21, 2, v20
    s_mov_b32 s32, 200000
    s_mov_b32 s41, 95125504
fl_15:
    buffer_load_dword v21, v20, s[16:19], s41 offen sc1
    s_waitcnt vmcnt(0)
    v_cmp_eq_u32 vcc, s59, v21
    s_nop 0
    s_cmp_eq_u64 vcc, -1
    s_cbranch_scc1 fld_16
    s_sleep 8
    s_sub_u32 s32, s32, 1
    s_cmp_lg_u32 s32, 0
    s_cbranch_scc1 fl_15
fld_16:
    v_lshl_add_u32 v48, v2, 1, v43
    v_lshl_add_u32 v49, v3, 1, v43
    v_lshl_add_u32 v50, v4, 1, v43
    v_lshl_add_u32 v51, v5, 1, v43
    v_lshl_add_u32 v52, v6, 1, v43
    v_lshl_add_u32 v53, v7, 1, v43
    v_lshl_add_u32 v54, v8, 1, v43
    s_mul_i32 s41, s81, 14336
    s_add_u32 s41, s41, s44
    s_mov_b32 s42, 14336
    buffer_load_dwordx4 a[0:3], v48, s[16:19], s41 offen sc1
    buffer_load_dwordx4 a[4:7], v48, s[16:19], s41 offen offset:1024 sc1
    buffer_load_dwordx4 a[56:59], v49, s[16:19], s41 offen sc1
    buffer_load_dwordx4 a[60:63], v49, s[16:19], s41 offen offset:1024 sc1
    buffer_load_dwordx4 a[112:115], v50, s[16:19], s41 offen sc1
    buffer_load_dwordx4 a[116:119], v50, s[16:19], s41 offen offset:1024 sc1
    buffer_load_dwordx4 a[120:123], v51, s[16:19], s41 offen sc1
    buffer_load_dwordx4 a[124:127], v51, s[16:19], s41 offen offset:1024 sc1
    buffer_load_dwordx4 a[128:131], v52, s[16:19], s41 offen sc1
    buffer_load_dwordx4 a[132:135], v52, s[16:19], s41 offen offset:1024 sc1
    buffer_load_dwordx4 a[136:139], v53, s[16:19], s41 offen sc1
    buffer_load_dwordx4 a[140:143], v53, s[16:19], s41 offen offset:1024 sc1
    buffer_load_dwordx4 a[144:147], v54, s[16:19], s41 offen sc1
    buffer_load_dwordx4 a[148:151], v54, s[16:19], s41 offen offset:1024 sc1
    s_add_u32 s41, s41, s42
    buffer_load_dwordx4 a[8:11], v48, s[16:19], s41 offen sc1
    buffer_load_dwordx4 a[12:15], v48, s[16:19], s41 offen offset:1024 sc1
    buffer_load_dwordx4 a[64:67], v49, s[16:19], s41 offen sc1
    buffer_load_dwordx4 a[68:71], v49, s[16:19], s41 offen offset:1024 sc1
    buffer_load_dwordx4 a[152:155], v50, s[16:19], s41 offen sc1
    buffer_load_dwordx4 a[156:159], v50, s[16:19], s41 offen offset:1024 sc1
    buffer_load_dwordx4 a[160:163], v51, s[16:19], s41 offen sc1
    buffer_load_dwordx4 a[164:167], v51, s[16:19], s41 offen offset:1024 sc1
    buffer_load_dwordx4 a[168:171], v52, s[16:19], s41 offen sc1
    buffer_load_dwordx4 a[172:175], v52, s[16:19], s41 offen offset:1024 sc1
    buffer_load_dwordx4 a[176:179], v53, s[16:19], s41 offen sc1
    buffer_load_dwordx4 a[180:183], v53, s[16:19], s41 offen offset:1024 sc1
    buffer_load_dwordx4 a[184:187], v54, s[16:19], s41 offen sc1
    buffer_load_dwordx4 a[188:191], v54, s[16:19], s41 offen offset:1024 sc1
    s_add_u32 s41, s41, s42
    buffer_load_dwordx4 a[16:19], v48, s[16:19], s41 offen sc1
    buffer_load_dwordx4 a[20:23], v48, s[16:19], s41 offen offset:1024 sc1
    buffer_load_dwordx4 a[72:75], v49, s[16:19], s41 offen sc1
    buffer_load_dwordx4 a[76:79], v49, s[16:19], s41 offen offset:1024 sc1
    buffer_load_dwordx4 a[192:195], v50, s[16:19], s41 offen sc1
    buffer_load_dwordx4 a[196:199], v50, s[16:19], s41 offen offset:1024 sc1
    buffer_load_dwordx4 a[200:203], v51, s[16:19], s41 offen sc1
    buffer_load_dwordx4 a[204:207], v51, s[16:19], s41 offen offset:1024 sc1
    buffer_load_dwordx4 a[208:211], v52, s[16:19], s41 offen sc1
    buffer_load_dwordx4 a[212:215], v52, s[16:19], s41 offen offset:1024 sc1
    buffer_load_dwordx4 a[216:219], v53, s[16:19], s41 offen sc1
    buffer_load_dwordx4 a[220:223], v53, s[16:19], s41 offen offset:1024 sc1
    buffer_load_dwordx4 a[224:227], v54, s[16:19], s41 offen sc1
    buffer_load_dwordx4 a[228:231], v54, s[16:19], s41 offen offset:1024 sc1
    s_add_u32 s41, s41, s42
    buffer_load_dwordx4 a[24:27], v48, s[16:19], s41 offen sc1
    buffer_load_dwordx4 a[28:31], v48, s[16:19], s41 offen offset:1024 sc1
    buffer_load_dwordx4 a[80:83], v49, s[16:19], s41 offen sc1
    buffer_load_dwordx4 a[84:87], v49, s[16:19], s41 offen offset:1024 sc1
    buffer_load_dwordx4 a[232:235], v50, s[16:19], s41 offen sc1
    buffer_load_dwordx4 a[236:239], v50, s[16:19], s41 offen offset:1024 sc1
    buffer_load_dwordx4 a[240:243], v51, s[16:19], s41 offen sc1
    buffer_load_dwordx4 a[244:247], v51, s[16:19], s41 offen offset:1024 sc1
    buffer_load_dwordx4 a[248:251], v52, s[16:19], s41 offen sc1
    buffer_load_dwordx4 a[252:255], v52, s[16:19], s41 offen offset:1024 sc1
    buffer_load_dwordx4 v[120:123], v53, s[16:19], s41 offen sc1
    buffer_load_dwordx4 v[124:127], v53, s[16:19], s41 offen offset:1024 sc1
    buffer_load_dwordx4 v[128:131], v54, s[16:19], s41 offen sc1
    buffer_load_dwordx4 v[132:135], v54, s[16:19], s41 offen offset:1024 sc1
    s_add_u32 s41, s41, s42
    buffer_load_dwordx4 a[32:35], v48, s[16:19], s41 offen sc1
    buffer_load_dwordx4 a[36:39], v48, s[16:19], s41 offen offset:1024 sc1
    buffer_load_dwordx4 a[88:91], v49, s[16:19], s41 offen sc1
    buffer_load_dwordx4 a[92:95], v49, s[16:19], s41 offen offset:1024 sc1
    buffer_load_dwordx4 v[136:139], v50, s[16:19], s41 offen sc1
    buffer_load_dwordx4 v[140:143], v50, s[16:19], s41 offen offset:1024 sc1
    buffer_load_dwordx4 v[144:147], v51, s[16:19], s41 offen sc1
    buffer_load_dwordx4 v[148:151], v51, s[16:19], s41 offen offset:1024 sc1
    buffer_load_dwordx4 v[152:155], v52, s[16:19], s41 offen sc1
    buffer_load_dwordx4 v[156:159], v52, s[16:19], s41 offen offset:1024 sc1
    buffer_load_dwordx4 v[160:163], v53, s[16:19], s41 offen sc1
    buffer_load_dwordx4 v[164:167], v53, s[16:19], s41 offen offset:1024 sc1
    buffer_load_dwordx4 v[168:171], v54, s[16:19], s41 offen sc1
    buffer_load_dwordx4 v[172:175], v54, s[16:19], s41 offen offset:1024 sc1
    s_add_u32 s41, s41, s42
    buffer_load_dwordx4 a[40:43], v48, s[16:19], s41 offen sc1
    buffer_load_dwordx4 a[44:47], v48, s[16:19], s41 offen offset:1024 sc1
    buffer_load_dwordx4 a[96:99], v49, s[16:19], s41 offen sc1
    buffer_load_dwordx4 a[100:103], v49, s[16:19], s41 offen offset:1024 sc1
    buffer_load_dwordx4 v[176:179], v50, s[16:19], s41 offen sc1
    buffer_load_dwordx4 v[180:183], v50, s[16:19], s41 offen offset:1024 sc1
    buffer_load_dwordx4 v[184:187], v51, s[16:19], s41 offen sc1
    buffer_load_dwordx4 v[188:191], v51, s[16:19], s41 offen offset:1024 sc1
    buffer_load_dwordx4 v[192:195], v52, s[16:19], s41 offen sc1
    buffer_load_dwordx4 v[196:199], v52, s[16:19], s41 offen offset:1024 sc1
    buffer_load_dwordx4 v[200:203], v53, s[16:19], s41 offen sc1
    buffer_load_dwordx4 v[204:207], v53, s[16:19], s41 offen offset:1024 sc1
    buffer_load_dwordx4 v[208:211], v54, s[16:19], s41 offen sc1
    buffer_load_dwordx4 v[212:215], v54, s[16:19], s41 offen offset:1024 sc1
    s_mul_i32 s41, s82, 14336
    s_add_u32 s41, s41, s44
    buffer_load_dwordx4 a[48:51], v48, s[16:19], s41 offen sc1
    buffer_load_dwordx4 a[52:55], v48, s[16:19], s41 offen offset:1024 sc1
    buffer_load_dwordx4 a[104:107], v49, s[16:19], s41 offen sc1
    buffer_load_dwordx4 a[108:111], v49, s[16:19], s41 offen offset:1024 sc1
    buffer_load_dwordx4 v[216:219], v50, s[16:19], s41 offen sc1
    buffer_load_dwordx4 v[220:223], v50, s[16:19], s41 offen offset:1024 sc1
    buffer_load_dwordx4 v[224:227], v51, s[16:19], s41 offen sc1
    buffer_load_dwordx4 v[228:231], v51, s[16:19], s41 offen offset:1024 sc1
    buffer_load_dwordx4 v[232:235], v52, s[16:19], s41 offen sc1
    buffer_load_dwordx4 v[236:239], v52, s[16:19], s41 offen offset:1024 sc1
    buffer_load_dwordx4 v[240:243], v53, s[16:19], s41 offen sc1
    buffer_load_dwordx4 v[244:247], v53, s[16:19], s41 offen offset:1024 sc1
    buffer_load_dwordx4 v[248:251], v54, s[16:19], s41 offen sc1
    buffer_load_dwordx4 v[252:255], v54, s[16:19], s41 offen offset:1024 sc1
    v_and_b32 v20, 1, v41
    v_lshrrev_b32 v21, 1, v41
    v_cmp_eq_u32 vcc, 1, v20
    v_add_u32 v22, s83, v20
    s_add_u32 s41, s83, 2
    v_mov_b32 v23, s41
    v_mov_b32 v24, s84
    v_cndmask_b32 v23, v23, v24, vcc
    s_sub_u32 s41, s80, 1
    s_not_b32 s42, s41
    v_mov_b32 v24, s41
    v_cndmask_b32 v9, -1, v24, vcc
    v_mov_b32 v24, s42
    v_cndmask_b32 v10, -1, v24, vcc
    v_and_b32 v25, 7, v42
    v_lshlrev_b32 v25, 5, v25
    v_lshl_add_u32 v25, v21, 3, v25
    v_lshl_add_u32 v11, v22, 9, v25
    v_lshl_add_u32 v12, v23, 9, v25
    s_mul_i32 s43, s28, 2560
    s_add_u32 s43, s43, 8192
    v_lshlrev_b32 v25, 3, v40
    v_lshl_add_u32 v25, v21, 6, v25
    v_add_u32 v13, s43, v25
    v_and_b32 v25, 3, v42
    v_lshrrev_b32 v26, 1, v25
    v_lshlrev_b32 v25, 7, v25
    v_lshl_add_u32 v25, v26, 6, v25
    v_lshrrev_b32 v26, 2, v40
    v_lshl_add_u32 v25, v26, 3, v25
    v_add_u32 v14, s43, v25
    s_lshl_b32 s43, s28, 11
    s_add_u32 s43, s43, 20480
    v_lshlrev_b32 v25, 9, v41
    v_lshl_add_u32 v25, v42, 4, v25
    v_add_u32 v15, s43, v25
    s_lshl_b32 s43, s28, 10
    s_add_u32 s43, s43, 20480
    v_and_b32 v25, 63, v40
    v_lshl_add_u32 v16, v25, 4, s43
    s_lshl_b32 s41, s28, 2
    v_add_u32 v26, s41, v41
    s_and_b32 s85, s29, 1
    s_bfe_u32 s86, s29, 0x10001
    s_lshr_b32 s41, s29, 2
    s_mul_i32 s41, s41, 3072
    s_lshl_b32 s42, s86, 10
    s_add_u32 s42, s42, s41
    s_lshl_b32 s43, s85, 9
    s_add_u32 s42, s42, s43
    v_lshrrev_b32 v27, 3, v42
    v_lshlrev_b32 v27, 8, v27
    v_lshl_add_u32 v27, v26, 5, v27
    v_and_b32 v28, 1, v42
    v_lshl_add_u32 v27, v28, 4, v27
    v_bfe_u32 v29, v42, 1, 2
    v_lshl_add_u32 v27, v29, 2, v27
    v_add_u32 v27, s42, v27
    s_add_u32 s42, s41, 2048
    s_lshl_b32 s43, s86, 9
    s_add_u32 s42, s42, s43
    s_lshl_b32 s43, s85, 2
    s_add_u32 s42, s42, s43
    v_bfe_u32 v29, v42, 2, 1
    v_lshlrev_b32 v29, 8, v29
    v_lshl_add_u32 v29, v26, 5, v29
    v_lshl_add_u32 v29, v28, 4, v29
    v_bfe_u32 v30, v42, 1, 1
    v_lshl_add_u32 v29, v30, 3, v29
    v_add_u32 v29, s42, v29
    v_mov_b32 v30, 2147483632
    v_cmp_gt_u32 vcc, 64, v40
    s_nop 1
    v_cndmask_b32 v17, v30, v27, vcc
    v_cndmask_b32 v29, v30, v29, vcc
    v_cmp_gt_u32 vcc, 8, v42
    s_nop 1
    v_cndmask_b32 v18, v30, v29, vcc
    v_mov_b32 v30, 0xf149f2ca
    v_cndmask_b32 v0, v30, 0, vcc
    s_lshl_b32 s47, s28, 13
    s_add_u32 s47, s47, 73285632
    s_lshl_b32 s41, s34, 10
    s_sub_u32 s47, s47, s41
    s_mov_b32 s48, 0
    s_cmp_lg_u32 s28, 0
    s_cbranch_scc1 fld_18
    v_and_b32 v20, 31, v40
    v_lshlrev_b32 v20, 6, v20
    v_add_u32 v20, 14356, v20
    s_mov_b32 s32, 200000
    s_mov_b32 s41, 95125504
fl_17:
    buffer_load_dword v21, v20, s[16:19], s41 offen sc1
    s_waitcnt vmcnt(0)
    v_cmp_eq_u32 vcc, s59, v21
    s_nop 0
    s_cmp_eq_u64 vcc, -1
    s_cbranch_scc1 fld_18
    s_sleep 4
    s_sub_u32 s32, s32, 1
    s_cmp_lg_u32 s32, 0
    s_cbranch_scc1 fl_17
fld_18:
    s_barrier
    v_and_b32 v20, 15, v40
    v_cmp_eq_u32 vcc, 8, v20
    v_lshlrev_b32 v20, 5, v20
    v_min_u32 v20, 252, v20
    v_cndmask_b32 v20, v20, 28, vcc
    s_mov_b32 s32, 200000
cm_19:
    buffer_load_dword v21, v20, s[24:27], 0 offen sc1
    s_waitcnt vmcnt(0)
    v_readlane_b32 s41, v21, 0
    s_mov_b32 s30, 0
    s_cmp_ge_u32 s41, 32
    s_cbranch_scc1 cmd_20
    s_mov_b32 s30, 1
    v_readlane_b32 s43, v21, 1
    s_nop 0
    s_add_u32 s41, s41, s43
    v_readlane_b32 s43, v21, 2
    s_nop 0
    s_add_u32 s41, s41, s43
    v_readlane_b32 s43, v21, 3
    s_nop 0
    s_add_u32 s41, s41, s43
    v_readlane_b32 s43, v21, 4
    s_nop 0
    s_add_u32 s41, s41, s43
    v_readlane_b32 s43, v21, 5
    s_nop 0
    s_add_u32 s41, s41, s43
    v_readlane_b32 s43, v21, 6
    s_nop 0
    s_add_u32 s41, s41, s43
    v_readlane_b32 s43, v21, 7
    s_nop 0
    s_add_u32 s41, s41, s43
    v_readlane_b32 s43, v21, 8
    s_nop 0
    s_add_u32 s41, s41, s43
    s_cmp_ge_u32 s41, 256
    s_cbranch_scc1 cmd_20
    s_sleep 2
    s_sub_u32 s32, s32, 1
    s_cmp_lg_u32 s32, 0
    s_cbranch_scc1 cm_19
cmd_20:
    s_cmp_eq_u32 s30, 0
    s_cbranch_scc1 nofix_21
    buffer_wbl2 sc1
    s_waitcnt vmcnt(0)
    s_mov_b32 s89, 244
    s_waitcnt vmcnt(0)
    s_barrier
    s_cmp_lg_u32 s28, 0
    s_cbranch_scc1 arr_22
    v_mov_b32 v20, s89
    v_mov_b32 v21, 1
    s_mov_b64 exec, 1
    buffer_atomic_add v21, v20, s[24:27], 0 offen sc1
    s_mov_b64 exec, -1
arr_22:
    s_cmp_lg_u32 s28, 0
    s_cbranch_scc1 cwd_24
    v_mov_b32 v20, 244
    v_mov_b32 v21, 32
    s_mov_b32 s32, 200000
    s_mov_b64 exec, 7
cw_23:
    buffer_load_dword v22, v20, s[24:27], 0 offen sc1
    s_waitcnt vmcnt(0)
    v_cmp_le_u32 vcc, v21, v22
    s_nop 0
    s_cmp_eq_u64 vcc, 7
    s_cbranch_scc1 cwd_24
    s_sleep 16
    s_sub_u32 s32, s32, 1
    s_cmp_lg_u32 s32, 0
    s_cbranch_scc1 cw_23
cwd_24:
    s_mov_b64 exec, -1
    s_barrier
nofix_21:
    buffer_load_dwordx4 v[88:91], v2, s[16:19], s47 offen offset:0 sc1
    buffer_load_dwordx4 v[92:95], v2, s[16:19], s47 offen offset:1024 sc1
    buffer_load_dwordx4 v[96:99], v2, s[16:19], s47 offen offset:2048 sc1
    buffer_load_dwordx4 v[100:103], v2, s[16:19], s47 offen offset:3072 sc1
    s_add_u32 s47, s47, 4096
    buffer_load_dwordx4 v[104:107], v2, s[16:19], s47 offen offset:0 sc1
    buffer_load_dwordx4 v[108:111], v2, s[16:19], s47 offen offset:1024 sc1
    buffer_load_dwordx4 v[112:115], v2, s[16:19], s47 offen offset:2048 sc1
    buffer_load_dwordx4 v[116:119], v2, s[16:19], s47 offen offset:3072 sc1
    s_add_u32 s47, s47, 28672
    v_mov_b32 v48, 0
    v_mov_b32 v49, 0
    v_mov_b32 v50, 0
    v_mov_b32 v51, 0
    v_mov_b32 v52, 0
    v_mov_b32 v53, 0
    v_mov_b32 v54, 0
    v_mov_b32 v55, 0
    v_mov_b32 v56, 0
    v_mov_b32 v57, 0
    v_mov_b32 v58, 0
    v_mov_b32 v59, 0
    v_mov_b32 v60, 0
    v_mov_b32 v61, 0
    v_mov_b32 v62, 0
    v_mov_b32 v63, 0
    v_mov_b32 v64, 0
    v_mov_b32 v65, 0
    v_mov_b32 v66, 0
    v_mov_b32 v67, 0
    v_mov_b32 v68, 0
    v_mov_b32 v69, 0
    v_mov_b32 v70, 0
    v_mov_b32 v71, 0
    v_mov_b32 v72, 0
    v_mov_b32 v73, 0
    v_mov_b32 v74, 0
    v_mov_b32 v75, 0
    v_mov_b32 v76, 0
    v_mov_b32 v77, 0
    v_mov_b32 v78, 0
    v_mov_b32 v79, 0
    v_mov_b32 v80, 0
    v_mov_b32 v81, 0
    v_mov_b32 v82, 0
    v_mov_b32 v83, 0
    v_mov_b32 v84, v0
    v_mov_b32 v85, 0
    v_mov_b32 v86, v0
    v_mov_b32 v87, 0
    s_waitcnt vmcnt(0) lgkmcnt(0)
    s_barrier
    s_setprio 3
L_T_step:
    s_mov_b32 s32, s31
    buffer_load_dwordx4 v[20:23], v2, s[16:19], s45 offen sc1
    buffer_load_dwordx4 v[24:27], v3, s[16:19], s45 offen sc1
L_T_pollA:
    buffer_load_dwordx4 v[20:23], v2, s[16:19], s45 offen sc1
    buffer_load_dwordx4 v[24:27], v3, s[16:19], s45 offen sc1
    s_waitcnt vmcnt(3)
    v_max3_u32 v19, v20, v21, v22
    v_max_u32 v19, v19, v23
    v_cmp_eq_u32 vcc, -1, v19
    s_cbranch_vccz polled_T
    s_sub_u32 s32, s32, 1
    s_cmp_lg_u32 s32, 0
    s_cbranch_scc1 L_T_pollA
    s_mov_b32 s31, 1
polled_T:
    v_smfmac_f32_16x16x64_bf16 v[48:51], v[20:23], a[0:7], v1
    ds_write_b64 v2, v[20:21] offset:0
    v_smfmac_f32_16x16x64_bf16 v[52:55], v[20:23], a[8:15], v1
    ds_write_b64 v2, v[22:23] offset:8
    s_waitcnt vmcnt(2)
    v_smfmac_f32_16x16x64_bf16 v[56:59], v[20:23], a[16:23], v1
    v_max3_u32 v19, v24, v25, v26
    v_max_u32 v19, v19, v27
    v_cmp_eq_u32 vcc, -1, v19
    s_cbranch_vccz L_T_f1ok
    s_mov_b32 s32, s31
L_T_pollB:
    buffer_load_dwordx4 v[24:27], v3, s[16:19], s45 offen sc1
    s_waitcnt vmcnt(1)
    v_max3_u32 v19, v24, v25, v26
    v_max_u32 v19, v19, v27
    v_cmp_eq_u32 vcc, -1, v19
    s_cbranch_vccz L_T_f1ok
    s_sub_u32 s32, s32, 1
    s_cmp_lg_u32 s32, 0
    s_cbranch_scc1 L_T_pollB
    s_mov_b32 s31, 1
L_T_f1ok:
    v_smfmac_f32_16x16x64_bf16 v[60:63], v[20:23], a[24:31], v1
    ds_write_b64 v3, v[24:25] offset:0
    v_smfmac_f32_16x16x64_bf16 v[64:67], v[20:23], a[32:39], v1
    ds_write_b64 v3, v[26:27] offset:8
    v_smfmac_f32_16x16x64_bf16 v[68:71], v[20:23], a[40:47], v1
    v_smfmac_f32_16x16x64_bf16 v[72:75], v[20:23], a[48:55], v1
    v_smfmac_f32_16x16x64_bf16 v[48:51], v[24:27], a[56:63], v1
    v_smfmac_f32_16x16x64_bf16 v[52:55], v[24:27], a[64:71], v1
    v_smfmac_f32_16x16x64_bf16 v[56:59], v[24:27], a[72:79], v1
    s_waitcnt lgkmcnt(0)
    s_barrier
    ds_read_b128 v[28:31], v4
    v_smfmac_f32_16x16x64_bf16 v[60:63], v[24:27], a[80:87], v1
    ds_read_b128 v[32:35], v5
    v_smfmac_f32_16x16x64_bf16 v[64:67], v[24:27], a[88:95], v1
    ds_read_b128 v[36:39], v6
    v_smfmac_f32_16x16x64_bf16 v[68:71], v[24:27], a[96:103], v1
    ds_read_b128 v[40:43], v7
    v_smfmac_f32_16x16x64_bf16 v[72:75], v[24:27], a[104:111], v1
    ds_read_b128 v[44:47], v8
    s_waitcnt lgkmcnt(4)
    v_smfmac_f32_16x16x64_bf16 v[48:51], v[28:31], a[112:119], v1
    s_waitcnt lgkmcnt(3)
    v_smfmac_f32_16x16x64_bf16 v[48:51], v[32:35], a[120:127], v1
    s_waitcnt lgkmcnt(2)
    v_smfmac_f32_16x16x64_bf16 v[48:51], v[36:39], a[128:135], v1
    s_waitcnt lgkmcnt(1)
    v_smfmac_f32_16x16x64_bf16 v[48:51], v[40:43], a[136:143], v1
    s_waitcnt lgkmcnt(0)
    v_smfmac_f32_16x16x64_bf16 v[48:51], v[44:47], a[144:151], v1
    v_smfmac_f32_16x16x64_bf16 v[52:55], v[28:31], a[152:159], v1
    s_waitcnt vmcnt(0)
    ds_read_b64 v[20:21], v11 offset:0
    v_smfmac_f32_16x16x64_bf16 v[52:55], v[32:35], a[160:167], v1
    ds_read_b64 v[22:23], v11 offset:16
    v_smfmac_f32_16x16x64_bf16 v[52:55], v[36:39], a[168:175], v1
    ds_read_b64 v[24:25], v11 offset:256
    v_smfmac_f32_16x16x64_bf16 v[52:55], v[40:43], a[176:183], v1
    v_add_f32 v48, v48, v49
    v_smfmac_f32_16x16x64_bf16 v[52:55], v[44:47], a[184:191], v1
    v_add_f32 v50, v50, v51
    v_smfmac_f32_16x16x64_bf16 v[56:59], v[28:31], a[192:199], v1
    ds_read_b64 v[26:27], v11 offset:272
    v_smfmac_f32_16x16x64_bf16 v[56:59], v[32:35], a[200:207], v1
    v_smfmac_f32_16x16x64_bf16 v[56:59], v[36:39], a[208:215], v1
    v_smfmac_f32_16x16x64_bf16 v[56:59], v[40:43], a[216:223], v1
    v_add_f32 v52, v52, v53
    v_smfmac_f32_16x16x64_bf16 v[56:59], v[44:47], a[224:231], v1
    v_add_f32 v54, v54, v55
    v_smfmac_f32_16x16x64_bf16 v[60:63], v[28:31], a[232:239], v1
    v_cvt_pk_bf16_f32 v55, v50, v54
    v_smfmac_f32_16x16x64_bf16 v[60:63], v[32:35], a[240:247], v1
    v_cvt_pk_bf16_f32 v54, v48, v52
    v_smfmac_f32_16x16x64_bf16 v[60:63], v[36:39], a[248:255], v1
    ds_write_b64 v13, v[54:55] offset:0
    v_smfmac_f32_16x16x64_bf16 v[60:63], v[40:43], v[120:127], v1
    ds_read_b64_tr_b16 v[48:49], v14 offset:0
    v_add_f32 v56, v56, v57
    v_smfmac_f32_16x16x64_bf16 v[60:63], v[44:47], v[128:135], v1
    v_add_f32 v58, v58, v59
    v_smfmac_f32_16x16x64_bf16 v[64:67], v[28:31], v[136:143], v1
    v_smfmac_f32_16x16x64_bf16 v[64:67], v[32:35], v[144:151], v1
    v_smfmac_f32_16x16x64_bf16 v[64:67], v[36:39], v[152:159], v1
    v_smfmac_f32_16x16x64_bf16 v[64:67], v[40:43], v[160:167], v1
    v_add_f32 v60, v60, v61
    v_smfmac_f32_16x16x64_bf16 v[64:67], v[44:47], v[168:175], v1
    v_add_f32 v62, v62, v63
    v_smfmac_f32_16x16x64_bf16 v[68:71], v[28:31], v[176:183], v1
    v_cvt_pk_bf16_f32 v63, v58, v62
    v_smfmac_f32_16x16x64_bf16 v[68:71], v[32:35], v[184:191], v1
    v_cvt_pk_bf16_f32 v62, v56, v60
    v_smfmac_f32_16x16x64_bf16 v[68:71], v[36:39], v[192:199], v1
    ds_write_b64 v13, v[62:63] offset:640
    v_smfmac_f32_16x16x64_bf16 v[68:71], v[40:43], v[200:207], v1
    ds_read_b64_tr_b16 v[50:51], v14 offset:640
    v_add_f32 v64, v64, v65
    v_smfmac_f32_16x16x64_bf16 v[68:71], v[44:47], v[208:215], v1
    v_add_f32 v66, v66, v67
    ds_read_b64 v[56:57], v12 offset:0
    ds_read_b64 v[58:59], v12 offset:16
    v_smfmac_f32_16x16x64_bf16 v[72:75], v[28:31], v[216:223], v1
    ds_read_b64 v[60:61], v12 offset:256
    ds_read_b64 v[62:63], v12 offset:272
    v_smfmac_f32_16x16x64_bf16 v[72:75], v[32:35], v[224:231], v1
    v_smfmac_f32_16x16x64_bf16 v[72:75], v[36:39], v[232:239], v1
    v_smfmac_f32_16x16x64_bf16 v[72:75], v[40:43], v[240:247], v1
    v_add_f32 v68, v68, v69
    v_smfmac_f32_16x16x64_bf16 v[72:75], v[44:47], v[248:255], v1
    v_add_f32 v70, v70, v71
    v_cvt_pk_bf16_f32 v71, v66, v70
    v_cvt_pk_bf16_f32 v70, v64, v68
    ds_write_b64 v13, v[70:71] offset:1280
    ds_read_b64_tr_b16 v[52:53], v14 offset:1280
    s_nop 2
    v_add_f32 v72, v72, v73
    v_add_f32 v74, v74, v75
    v_cvt_pk_bf16_f32 v75, v74, v74
    v_cvt_pk_bf16_f32 v74, v72, v72
    ds_write_b64 v13, v[74:75] offset:1920
    ds_read_b64_tr_b16 v[54:55], v14 offset:1920
    s_waitcnt lgkmcnt(4)
    v_smfmac_f32_16x16x64_bf16 v[76:79], v[48:51], v[88:95], v1
    v_and_b32 v56, v56, v9
    v_and_b32 v57, v57, v10
    v_and_b32 v58, v58, v9
    v_smfmac_f32_16x16x64_bf16 v[80:83], v[48:51], v[96:103], v1
    v_and_b32 v59, v59, v10
    v_and_b32 v60, v60, v9
    v_and_b32 v61, v61, v10
    v_smfmac_f32_16x16x64_bf16 v[84:87], v[48:51], v[20:27], v1
    v_and_b32 v62, v62, v9
    v_and_b32 v63, v63, v10
    s_waitcnt lgkmcnt(0)
    v_smfmac_f32_16x16x64_bf16 v[76:79], v[52:55], v[104:111], v1
    v_smfmac_f32_16x16x64_bf16 v[80:83], v[52:55], v[112:119], v1
    v_smfmac_f32_16x16x64_bf16 v[84:87], v[52:55], v[56:63], v1
    s_nop 3
    v_add_f32 v64, v76, v77
    v_add_f32 v68, v78, v79
    v_add_f32 v65, v80, v81
    v_add_f32 v69, v82, v83
    v_add_f32 v66, v84, v85
    v_add_f32 v70, v86, v87
    ds_write_b96 v15, v[64:66]
    ds_write_b96 v15, v[68:70] offset:256
    s_cmp_ge_u32 s28, 2
    s_waitcnt lgkmcnt(0)
    s_barrier
    s_cbranch_scc1 L_T_idle
    ds_read_b128 v[48:51], v16 offset:0
    ds_read_b128 v[52:55], v16 offset:2048
    ds_read_b128 v[56:59], v16 offset:4096
    ds_read_b128 v[60:63], v16 offset:6144
    s_waitcnt lgkmcnt(2)
    v_pk_add_f32 v[48:49], v[48:49], v[52:53]
    v_add_f32 v50, v50, v54
    s_waitcnt lgkmcnt(0)
    v_pk_add_f32 v[56:57], v[56:57], v[60:61]
    v_add_f32 v58, v58, v62
    v_pk_add_f32 v[48:49], v[48:49], v[56:57]
    v_add_f32 v50, v50, v58
    v_max3_f32 v52, v48, v49, v50
    s_nop 1
    v_max_f32_dpp v52, v52, v52 quad_perm:[1,0,3,2] row_mask:0xf bank_mask:0xf
    s_nop 1
    v_max_f32_dpp v52, v52, v52 quad_perm:[2,3,0,1] row_mask:0xf bank_mask:0xf
    s_nop 1
    v_max_f32_dpp v52, v52, v52 row_half_mirror row_mask:0xf bank_mask:0xf
    s_nop 1
    v_max_f32_dpp v52, v52, v52 row_mirror row_mask:0xf bank_mask:0xf
    v_sub_f32 v48, v48, v52
    v_sub_f32 v49, v49, v52
    v_sub_f32 v50, v50, v52
    v_exp_f32 v48, v48
    v_exp_f32 v49, v49
    v_exp_f32 v50, v50
    v_add_f32 v53, v48, v49
    v_add_f32 v53, v53, v50
    s_nop 1
    v_add_f32_dpp v53, v53, v53 quad_perm:[1,0,3,2] row_mask:0xf bank_mask:0xf
    s_nop 1
    v_add_f32_dpp v53, v53, v53 quad_perm:[2,3,0,1] row_mask:0xf bank_mask:0xf
    s_nop 1
    v_add_f32_dpp v53, v53, v53 row_half_mirror row_mask:0xf bank_mask:0xf
    s_nop 1
    v_add_f32_dpp v53, v53, v53 row_mirror row_mask:0xf bank_mask:0xf
    v_rcp_f32 v53, v53
    s_nop 0
    v_mul_f32 v48, v48, v53
    v_mul_f32 v49, v49, v53
    v_cvt_pk_bf16_f32 v54, v48, v49
    buffer_store_dword v54, v17, s[16:19], s46 offen
    v_mul_f32 v50, v50, v53
    v_cvt_pk_bf16_f32 v55, v50, v50
    buffer_store_dword v55, v18, s[16:19], s46 offen
    s_cmp_eq_u32 s30, 0
    s_cbranch_scc1 L_T_nofb
    buffer_store_dword v54, v17, s[16:19], s46 offen sc1
    buffer_store_dword v55, v18, s[16:19], s46 offen sc1
L_T_nofb:
    s_branch L_T_join
L_T_idle:
    s_sleep 8
L_T_join:
    v_mov_b32 v48, 0
    v_mov_b32 v49, 0
    v_mov_b32 v50, 0
    v_mov_b32 v51, 0
    v_mov_b32 v52, 0
    v_mov_b32 v53, 0
    v_mov_b32 v54, 0
    v_mov_b32 v55, 0
    v_mov_b32 v56, 0
    v_mov_b32 v57, 0
    v_mov_b32 v58, 0
    v_mov_b32 v59, 0
    v_mov_b32 v60, 0
    v_mov_b32 v61, 0
    v_mov_b32 v62, 0
    v_mov_b32 v63, 0
    v_mov_b32 v64, 0
    v_mov_b32 v65, 0
    v_mov_b32 v66, 0
    v_mov_b32 v67, 0
    v_mov_b32 v68, 0
    v_mov_b32 v69, 0
    v_mov_b32 v70, 0
    v_mov_b32 v71, 0
    v_mov_b32 v72, 0
    v_mov_b32 v73, 0
    v_mov_b32 v74, 0
    v_mov_b32 v75, 0
    v_mov_b32 v76, 0
    v_mov_b32 v77, 0
    v_mov_b32 v78, 0
    v_mov_b32 v79, 0
    v_mov_b32 v80, 0
    v_mov_b32 v81, 0
    v_mov_b32 v82, 0
    v_mov_b32 v83, 0
    v_mov_b32 v84, v0
    v_mov_b32 v85, 0
    v_mov_b32 v86, v0
    v_mov_b32 v87, 0
    buffer_load_dwordx4 v[88:91], v2, s[16:19], s47 offen offset:0 sc1
    buffer_load_dwordx4 v[92:95], v2, s[16:19], s47 offen offset:1024 sc1
    buffer_load_dwordx4 v[96:99], v2, s[16:19], s47 offen offset:2048 sc1
    buffer_load_dwordx4 v[100:103], v2, s[16:19], s47 offen offset:3072 sc1
    s_add_u32 s47, s47, 4096
    buffer_load_dwordx4 v[104:107], v2, s[16:19], s47 offen offset:0 sc1
    buffer_load_dwordx4 v[108:111], v2, s[16:19], s47 offen offset:1024 sc1
    buffer_load_dwordx4 v[112:115], v2, s[16:19], s47 offen offset:2048 sc1
    buffer_load_dwordx4 v[116:119], v2, s[16:19], s47 offen offset:3072 sc1
    s_add_u32 s47, s47, 28672
    s_sleep 3
    s_add_u32 s45, s45, 7168
    s_add_u32 s46, s46, 12288
    s_add_u32 s33, s33, 1
    s_cmp_lt_u32 s33, 63
    s_cbranch_scc1 L_T_step
    s_cmp_lg_u32 s29, 0
    s_cbranch_scc1 L_T_end
    v_mov_b32 v20, 95141888
    v_mov_b32 v21, s59
    s_mov_b64 exec, 1
    buffer_store_dword v21, v20, s[16:19], 0 offen sc1
    s_mov_b64 exec, -1
L_T_end:
    s_waitcnt vmcnt(0)
    s_endpgm
L_role_V:
    v_and_b32 v40, 63, v0
    v_lshrrev_b32 v41, 4, v40
    v_and_b32 v42, 15, v40
    v_and_b32 v20, 1, v0
    v_cmp_eq_u32 vcc, 0, v20
    v_mov_b32 v20, 0xEEEE
    v_mov_b32 v21, 0x4444
    v_cndmask_b32 v1, v20, v21, vcc
    s_lshl_b32 s41, s28, 1
    s_add_u32 s42, s41, 0
    s_sub_u32 s43, s42, 7
    s_cmp_ge_u32 s42, 7
    s_cselect_b32 s34, s43, s42
    s_lshl_b32 s42, s34, 10
    v_lshl_add_u32 v2, v40, 4, s42
    s_add_u32 s42, s41, 1
    s_sub_u32 s43, s42, 7
    s_cmp_ge_u32 s42, 7
    s_cselect_b32 s35, s43, s42
    s_lshl_b32 s42, s35, 10
    v_lshl_add_u32 v3, v40, 4, s42
    s_add_u32 s42, s41, 2
    s_sub_u32 s43, s42, 7
    s_cmp_ge_u32 s42, 7
    s_cselect_b32 s36, s43, s42
    s_lshl_b32 s42, s36, 10
    v_lshl_add_u32 v4, v40, 4, s42
    s_add_u32 s42, s41, 3
    s_sub_u32 s43, s42, 7
    s_cmp_ge_u32 s42, 7
    s_cselect_b32 s37, s43, s42
    s_lshl_b32 s42, s37, 10
    v_lshl_add_u32 v5, v40, 4, s42
    s_add_u32 s42, s41, 4
    s_sub_u32 s43, s42, 7
    s_cmp_ge_u32 s42, 7
    s_cselect_b32 s38, s43, s42
    s_lshl_b32 s42, s38, 10
    v_lshl_add_u32 v6, v40, 4, s42
    s_add_u32 s42, s41, 5
    s_sub_u32 s43, s42, 7
    s_cmp_ge_u32 s42, 7
    s_cselect_b32 s39, s43, s42
    s_lshl_b32 s42, s39, 10
    v_lshl_add_u32 v7, v40, 4, s42
    s_add_u32 s42, s41, 6
    s_sub_u32 s43, s42, 7
    s_cmp_ge_u32 s42, 7
    s_cselect_b32 s40, s43, s42
    s_lshl_b32 s42, s40, 10
    v_lshl_add_u32 v8, v40, 4, s42
    s_mov_b32 s31, 200000
    s_mov_b32 s33, 0
    s_mov_b32 s45, 71565312
    s_mov_b32 s46, 72024064
    s_sub_u32 s80, s29, 16
    v_lshlrev_b32 v9, 4, v40
    s_mul_i32 s58, s28, 24576
    s_add_u32 s58, s58, 16384
    v_add_u32 v15, s58, v9
    s_lshl_b32 s44, s28, 2
    s_mul_i32 s44, s44, 401408
    s_mul_i32 s41, s80, 28672
    s_add_u32 s44, s44, s41
    s_add_u32 s81, s44, 6422528
    s_mul_i32 s41, s28, 3072
    v_add_u32 v10, s41, v9
    s_lshl_b32 s41, s28, 10
    s_add_u32 s41, s41, 8192
    v_add_u32 v11, s41, v9
    v_and_b32 v20, 1, v41
    v_lshlrev_b32 v21, 4, v42
    v_lshl_add_u32 v21, v20, 3, v21
    v_lshrrev_b32 v22, 1, v41
    v_lshl_add_u32 v21, v22, 8, v21
    s_lshl_b32 s41, s28, 9
    s_add_u32 s41, s41, 8192
    v_add_u32 v12, s41, v21
    s_lshl_b32 s41, s28, 2
    v_add_u32 v22, s41, v41
    v_lshrrev_b32 v23, 3, v42
    v_lshlrev_b32 v23, 8, v23
    v_lshl_add_u32 v23, v22, 5, v23
    v_and_b32 v24, 1, v42
    v_lshl_add_u32 v23, v24, 4, v23
    v_bfe_u32 v24, v42, 1, 2
    v_lshl_add_u32 v23, v24, 2, v23
    s_lshl_b32 s41, s80, 9
    v_add_u32 v23, s41, v23
    v_mul_u32_u24 v24, 896, v22
    v_lshl_add_u32 v24, v42, 2, v24
    s_lshl_b32 s41, s80, 6
    v_add_u32 v24, s41, v24
    v_mov_b32 v25, 2147483632
    v_cmp_gt_u32 vcc, 64, v40
    s_nop 1
    v_cndmask_b32 v13, v25, v23, vcc
    v_cndmask_b32 v14, v25, v24, vcc
    v_and_b32 v24, 3, v40
    s_lshl_b32 s41, s28, 2
    v_add_u32 v24, s41, v24
    v_mul_u32_u24 v24, 14, v24
    v_add_u32 v24, s80, v24
    v_lshlrev_b32 v24, 6, v24
    v_add_u32 v16, 73269248, v24
    s_mov_b32 s56, 0
    v_mov_b32 v156, 0
    v_mov_b32 v157, 0
    v_mov_b32 v158, 0
    v_mov_b32 v159, 0
    s_mov_b32 s48, 0
    s_mov_b32 s57, 0
    s_lshl_b32 s41, s28, 2
    s_mul_i32 s41, s41, 28672
    s_lshl_b32 s42, s80, 11
    s_add_u32 s41, s41, s42
    s_add_u32 s47, s41, 12845056
    v_mov_b32 v17, v13
    v_mov_b32 v13, 2147483632
    s_mov_b32 s82, s47
    s_mov_b32 s31, 1
    s_mov_b32 s30, 0
    s_mov_b32 s33, 100
    s_branch L_V_step
L_V_dryret:
    s_waitcnt vmcnt(0) lgkmcnt(0)
    v_mov_b32 v13, v17
    s_mov_b32 s47, s82
    s_mov_b32 s31, 200000
    s_mov_b32 s33, 0
    s_mov_b32 s56, 0
    s_mov_b32 s45, 71565312
    s_mov_b32 s46, 72024064
    v_lshrrev_b32 v40, 4, v9
    s_and_b32 s42, s80, 14
    s_mul_i32 s43, s28, 56
    s_add_u32 s42, s42, s43
    v_and_b32 v20, 3, v40
    v_mul_u32_u24 v20, 14, v20
    v_bfe_u32 v21, v40, 2, 1
    v_add3_u32 v20, v20, v21, s42
    v_lshlrev_b32 v20, 6, v20
    v_add_u32 v20, 16, v20
    s_mov_b32 s32, 200000
    s_mov_b32 s41, 95125504
fl_25:
    buffer_load_dword v21, v20, s[16:19], s41 offen sc1
    s_waitcnt vmcnt(0)
    v_cmp_eq_u32 vcc, s59, v21
    s_nop 0
    s_cmp_eq_u64 vcc, -1
    s_cbranch_scc1 fld_26
    s_sleep 8
    s_sub_u32 s32, s32, 1
    s_cmp_lg_u32 s32, 0
    s_cbranch_scc1 fl_25
fld_26:
    v_sub_u32 v43, 0, v9
    v_lshl_add_u32 v48, v2, 1, v43
    v_lshl_add_u32 v49, v3, 1, v43
    v_lshl_add_u32 v50, v4, 1, v43
    v_lshl_add_u32 v51, v5, 1, v43
    v_lshl_add_u32 v52, v6, 1, v43
    v_lshl_add_u32 v53, v7, 1, v43
    v_lshl_add_u32 v54, v8, 1, v43
    s_mov_b32 m0, s58
    s_add_u32 s41, s81, 0
    buffer_load_dwordx4 a[0:3], v48, s[16:19], s41 offen sc1
    buffer_load_dwordx4 a[4:7], v48, s[16:19], s41 offen offset:1024 sc1
    buffer_load_dwordx4 a[64:67], v49, s[16:19], s41 offen sc1
    buffer_load_dwordx4 a[68:71], v49, s[16:19], s41 offen offset:1024 sc1
    buffer_load_dwordx4 a[128:131], v50, s[16:19], s41 offen sc1
    buffer_load_dwordx4 a[132:135], v50, s[16:19], s41 offen offset:1024 sc1
    buffer_load_dwordx4 a[136:139], v51, s[16:19], s41 offen sc1
    buffer_load_dwordx4 a[140:143], v51, s[16:19], s41 offen offset:1024 sc1
    buffer_load_dwordx4 a[144:147], v52, s[16:19], s41 offen sc1
    buffer_load_dwordx4 a[148:151], v52, s[16:19], s41 offen offset:1024 sc1
    buffer_load_dwordx4 a[152:155], v53, s[16:19], s41 offen sc1
    buffer_load_dwordx4 a[156:159], v53, s[16:19], s41 offen offset:1024 sc1
    buffer_load_dwordx4 a[160:163], v54, s[16:19], s41 offen sc1
    buffer_load_dwordx4 a[164:167], v54, s[16:19], s41 offen offset:1024 sc1
    s_add_u32 s41, s81, 14336
    buffer_load_dwordx4 a[8:11], v48, s[16:19], s41 offen sc1
    buffer_load_dwordx4 a[12:15], v48, s[16:19], s41 offen offset:1024 sc1
    buffer_load_dwordx4 a[72:75], v49, s[16:19], s41 offen sc1
    buffer_load_dwordx4 a[76:79], v49, s[16:19], s41 offen offset:1024 sc1
    buffer_load_dwordx4 v50, s[16:19], s41 offen sc1 lds
    buffer_load_dwordx4 v50, s[16:19], s41 offen offset:1024 sc1 lds
    s_add_u32 m0, m0, 2048
    buffer_load_dwordx4 a[168:171], v51, s[16:19], s41 offen sc1
    buffer_load_dwordx4 a[172:175], v51, s[16:19], s41 offen offset:1024 sc1
    buffer_load_dwordx4 a[176:179], v52, s[16:19], s41 offen sc1
    buffer_load_dwordx4 a[180:183], v52, s[16:19], s41 offen offset:1024 sc1
    buffer_load_dwordx4 v53, s[16:19], s41 offen sc1 lds
    buffer_load_dwordx4 v53, s[16:19], s41 offen offset:1024 sc1 lds
    s_add_u32 m0, m0, 2048
    buffer_load_dwordx4 a[184:187], v54, s[16:19], s41 offen sc1
    buffer_load_dwordx4 a[188:191], v54, s[16:19], s41 offen offset:1024 sc1
    s_add_u32 s41, s81, 401408
    buffer_load_dwordx4 a[16:19], v48, s[16:19], s41 offen sc1
    buffer_load_dwordx4 a[20:23], v48, s[16:19], s41 offen offset:1024 sc1
    buffer_load_dwordx4 a[80:83], v49, s[16:19], s41 offen sc1
    buffer_load_dwordx4 a[84:87], v49, s[16:19], s41 offen offset:1024 sc1
    buffer_load_dwordx4 a[192:195], v50, s[16:19], s41 offen sc1
    buffer_load_dwordx4 a[196:199], v50, s[16:19], s41 offen offset:1024 sc1
    buffer_load_dwordx4 v51, s[16:19], s41 offen sc1 lds
    buffer_load_dwordx4 v51, s[16:19], s41 offen offset:1024 sc1 lds
    s_add_u32 m0, m0, 2048
    buffer_load_dwordx4 a[200:203], v52, s[16:19], s41 offen sc1
    buffer_load_dwordx4 a[204:207], v52, s[16:19], s41 offen offset:1024 sc1
    buffer_load_dwordx4 a[208:211], v53, s[16:19], s41 offen sc1
    buffer_load_dwordx4 a[212:215], v53, s[16:19], s41 offen offset:1024 sc1
    buffer_load_dwordx4 v54, s[16:19], s41 offen sc1 lds
    buffer_load_dwordx4 v54, s[16:19], s41 offen offset:1024 sc1 lds
    s_add_u32 m0, m0, 2048
    s_add_u32 s41, s81, 415744
    buffer_load_dwordx4 a[24:27], v48, s[16:19], s41 offen sc1
    buffer_load_dwordx4 a[28:31], v48, s[16:19], s41 offen offset:1024 sc1
    buffer_load_dwordx4 a[88:91], v49, s[16:19], s41 offen sc1
    buffer_load_dwordx4 a[92:95], v49, s[16:19], s41 offen offset:1024 sc1
    buffer_load_dwordx4 a[216:219], v50, s[16:19], s41 offen sc1
    buffer_load_dwordx4 a[220:223], v50, s[16:19], s41 offen offset:1024 sc1
    buffer_load_dwordx4 a[224:227], v51, s[16:19], s41 offen sc1
    buffer_load_dwordx4 a[228:231], v51, s[16:19], s41 offen offset:1024 sc1
    buffer_load_dwordx4 v52, s[16:19], s41 offen sc1 lds
    buffer_load_dwordx4 v52, s[16:19], s41 offen offset:1024 sc1 lds
    s_add_u32 m0, m0, 2048
    buffer_load_dwordx4 a[232:235], v53, s[16:19], s41 offen sc1
    buffer_load_dwordx4 a[236:239], v53, s[16:19], s41 offen offset:1024 sc1
    buffer_load_dwordx4 a[240:243], v54, s[16:19], s41 offen sc1
    buffer_load_dwordx4 a[244:247], v54, s[16:19], s41 offen offset:1024 sc1
    s_add_u32 s41, s81, 802816
    buffer_load_dwordx4 a[32:35], v48, s[16:19], s41 offen sc1
    buffer_load_dwordx4 a[36:39], v48, s[16:19], s41 offen offset:1024 sc1
    buffer_load_dwordx4 a[96:99], v49, s[16:19], s41 offen sc1
    buffer_load_dwordx4 a[100:103], v49, s[16:19], s41 offen offset:1024 sc1
    buffer_load_dwordx4 v50, s[16:19], s41 offen sc1 lds
    buffer_load_dwordx4 v50, s[16:19], s41 offen offset:1024 sc1 lds
    s_add_u32 m0, m0, 2048
    buffer_load_dwordx4 a[248:251], v51, s[16:19], s41 offen sc1
    buffer_load_dwordx4 a[252:255], v51, s[16:19], s41 offen offset:1024 sc1
    buffer_load_dwordx4 v[160:163], v52, s[16:19], s41 offen sc1
    buffer_load_dwordx4 v[164:167], v52, s[16:19], s41 offen offset:1024 sc1
    buffer_load_dwordx4 v53, s[16:19], s41 offen sc1 lds
    buffer_load_dwordx4 v53, s[16:19], s41 offen offset:1024 sc1 lds
    s_add_u32 m0, m0, 2048
    buffer_load_dwordx4 v[168:171], v54, s[16:19], s41 offen sc1
    buffer_load_dwordx4 v[172:175], v54, s[16:19], s41 offen offset:1024 sc1
    s_add_u32 s41, s81, 817152
    buffer_load_dwordx4 a[40:43], v48, s[16:19], s41 offen sc1
    buffer_load_dwordx4 a[44:47], v48, s[16:19], s41 offen offset:1024 sc1
    buffer_load_dwordx4 a[104:107], v49, s[16:19], s41 offen sc1
    buffer_load_dwordx4 a[108:111], v49, s[16:19], s41 offen offset:1024 sc1
    buffer_load_dwordx4 v[176:179], v50, s[16:19], s41 offen sc1
    buffer_load_dwordx4 v[180:183], v50, s[16:19], s41 offen offset:1024 sc1
    buffer_load_dwordx4 v51, s[16:19], s41 offen sc1 lds
    buffer_load_dwordx4 v51, s[16:19], s41 offen offset:1024 sc1 lds
    s_add_u32 m0, m0, 2048
    buffer_load_dwordx4 v[184:187], v52, s[16:19], s41 offen sc1
    buffer_load_dwordx4 v[188:191], v52, s[16:19], s41 offen offset:1024 sc1
    buffer_load_dwordx4 v[192:195], v53, s[16:19], s41 offen sc1
    buffer_load_dwordx4 v[196:199], v53, s[16:19], s41 offen offset:1024 sc1
    buffer_load_dwordx4 v54, s[16:19], s41 offen sc1 lds
    buffer_load_dwordx4 v54, s[16:19], s41 offen offset:1024 sc1 lds
    s_add_u32 m0, m0, 2048
    s_add_u32 s41, s81, 1204224
    buffer_load_dwordx4 a[48:51], v48, s[16:19], s41 offen sc1
    buffer_load_dwordx4 a[52:55], v48, s[16:19], s41 offen offset:1024 sc1
    buffer_load_dwordx4 a[112:115], v49, s[16:19], s41 offen sc1
    buffer_load_dwordx4 a[116:119], v49, s[16:19], s41 offen offset:1024 sc1
    buffer_load_dwordx4 v[200:203], v50, s[16:19], s41 offen sc1
    buffer_load_dwordx4 v[204:207], v50, s[16:19], s41 offen offset:1024 sc1
    buffer_load_dwordx4 v[208:211], v51, s[16:19], s41 offen sc1
    buffer_load_dwordx4 v[212:215], v51, s[16:19], s41 offen offset:1024 sc1
    buffer_load_dwordx4 v52, s[16:19], s41 offen sc1 lds
    buffer_load_dwordx4 v52, s[16:19], s41 offen offset:1024 sc1 lds
    s_add_u32 m0, m0, 2048
    buffer_load_dwordx4 v[216:219], v53, s[16:19], s41 offen sc1
    buffer_load_dwordx4 v[220:223], v53, s[16:19], s41 offen offset:1024 sc1
    buffer_load_dwordx4 v[224:227], v54, s[16:19], s41 offen sc1
    buffer_load_dwordx4 v[228:231], v54, s[16:19], s41 offen offset:1024 sc1
    s_add_u32 s41, s81, 1218560
    buffer_load_dwordx4 a[56:59], v48, s[16:19], s41 offen sc1
    buffer_load_dwordx4 a[60:63], v48, s[16:19], s41 offen offset:1024 sc1
    buffer_load_dwordx4 a[120:123], v49, s[16:19], s41 offen sc1
    buffer_load_dwordx4 a[124:127], v49, s[16:19], s41 offen offset:1024 sc1
    buffer_load_dwordx4 v50, s[16:19], s41 offen sc1 lds
    buffer_load_dwordx4 v50, s[16:19], s41 offen offset:1024 sc1 lds
    s_add_u32 m0, m0, 2048
    buffer_load_dwordx4 v[232:235], v51, s[16:19], s41 offen sc1
    buffer_load_dwordx4 v[236:239], v51, s[16:19], s41 offen offset:1024 sc1
    buffer_load_dwordx4 v[240:243], v52, s[16:19], s41 offen sc1
    buffer_load_dwordx4 v[244:247], v52, s[16:19], s41 offen offset:1024 sc1
    buffer_load_dwordx4 v53, s[16:19], s41 offen sc1 lds
    buffer_load_dwordx4 v53, s[16:19], s41 offen offset:1024 sc1 lds
    s_add_u32 m0, m0, 2048
    buffer_load_dwordx4 v[248:251], v54, s[16:19], s41 offen sc1
    buffer_load_dwordx4 v[252:255], v54, s[16:19], s41 offen offset:1024 sc1
    v_mov_b32 v48, 0
    v_mov_b32 v49, 0
    v_mov_b32 v50, 0
    v_mov_b32 v51, 0
    v_mov_b32 v52, 0
    v_mov_b32 v53, 0
    v_mov_b32 v54, 0
    v_mov_b32 v55, 0
    v_mov_b32 v56, 0
    v_mov_b32 v57, 0
    v_mov_b32 v58, 0
    v_mov_b32 v59, 0
    v_mov_b32 v60, 0
    v_mov_b32 v61, 0
    v_mov_b32 v62, 0
    v_mov_b32 v63, 0
    v_mov_b32 v64, 0
    v_mov_b32 v65, 0
    v_mov_b32 v66, 0
    v_mov_b32 v67, 0
    v_mov_b32 v68, 0
    v_mov_b32 v69, 0
    v_mov_b32 v70, 0
    v_mov_b32 v71, 0
    v_mov_b32 v72, 0
    v_mov_b32 v73, 0
    v_mov_b32 v74, 0
    v_mov_b32 v75, 0
    v_mov_b32 v76, 0
    v_mov_b32 v77, 0
    v_mov_b32 v78, 0
    v_mov_b32 v79, 0
    s_cmp_lg_u32 s28, 0
    s_cbranch_scc1 fld_28
    v_and_b32 v20, 31, v40
    v_lshlrev_b32 v20, 6, v20
    v_add_u32 v20, 14356, v20
    s_mov_b32 s32, 200000
    s_mov_b32 s41, 95125504
fl_27:
    buffer_load_dword v21, v20, s[16:19], s41 offen sc1
    s_waitcnt vmcnt(0)
    v_cmp_eq_u32 vcc, s59, v21
    s_nop 0
    s_cmp_eq_u64 vcc, -1
    s_cbranch_scc1 fld_28
    s_sleep 4
    s_sub_u32 s32, s32, 1
    s_cmp_lg_u32 s32, 0
    s_cbranch_scc1 fl_27
fld_28:
    s_barrier
    v_and_b32 v20, 15, v40
    v_cmp_eq_u32 vcc, 8, v20
    v_lshlrev_b32 v20, 5, v20
    v_min_u32 v20, 252, v20
    v_cndmask_b32 v20, v20, 28, vcc
    s_mov_b32 s32, 200000
cm_29:
    buffer_load_dword v21, v20, s[24:27], 0 offen sc1
    s_waitcnt vmcnt(0)
    v_readlane_b32 s41, v21, 0
    s_mov_b32 s30, 0
    s_cmp_ge_u32 s41, 32
    s_cbranch_scc1 cmd_30
    s_mov_b32 s30, 1
    v_readlane_b32 s43, v21, 1
    s_nop 0
    s_add_u32 s41, s41, s43
    v_readlane_b32 s43, v21, 2
    s_nop 0
    s_add_u32 s41, s41, s43
    v_readlane_b32 s43, v21, 3
    s_nop 0
    s_add_u32 s41, s41, s43
    v_readlane_b32 s43, v21, 4
    s_nop 0
    s_add_u32 s41, s41, s43
    v_readlane_b32 s43, v21, 5
    s_nop 0
    s_add_u32 s41, s41, s43
    v_readlane_b32 s43, v21, 6
    s_nop 0
    s_add_u32 s41, s41, s43
    v_readlane_b32 s43, v21, 7
    s_nop 0
    s_add_u32 s41, s41, s43
    v_readlane_b32 s43, v21, 8
    s_nop 0
    s_add_u32 s41, s41, s43
    s_cmp_ge_u32 s41, 256
    s_cbranch_scc1 cmd_30
    s_sleep 2
    s_sub_u32 s32, s32, 1
    s_cmp_lg_u32 s32, 0
    s_cbranch_scc1 cm_29
cmd_30:
    s_cmp_eq_u32 s30, 0
    s_cbranch_scc1 nofix_31
    buffer_wbl2 sc1
    s_waitcnt vmcnt(0)
    s_mov_b32 s89, 244
    s_waitcnt vmcnt(0)
    s_barrier
    s_cmp_lg_u32 s28, 0
    s_cbranch_scc1 arr_32
    v_mov_b32 v20, s89
    v_mov_b32 v21, 1
    s_mov_b64 exec, 1
    buffer_atomic_add v21, v20, s[24:27], 0 offen sc1
    s_mov_b64 exec, -1
arr_32:
    s_cmp_lg_u32 s28, 0
    s_cbranch_scc1 cwd_34
    v_mov_b32 v20, 244
    v_mov_b32 v21, 32
    s_mov_b32 s32, 200000
    s_mov_b64 exec, 7
cw_33:
    buffer_load_dword v22, v20, s[24:27], 0 offen sc1
    s_waitcnt vmcnt(0)
    v_cmp_le_u32 vcc, v21, v22
    s_nop 0
    s_cmp_eq_u64 vcc, 7
    s_cbranch_scc1 cwd_34
    s_sleep 16
    s_sub_u32 s32, s32, 1
    s_cmp_lg_u32 s32, 0
    s_cbranch_scc1 cw_33
cwd_34:
    s_mov_b64 exec, -1
    s_barrier
nofix_31:
    s_waitcnt vmcnt(0)
    s_cmp_lg_u32 s29, 16
    s_cbranch_scc1 L_V_nold
    v_mov_b32 v20, 95142080
    v_mov_b32 v21, s59
    s_mov_b64 exec, 1
    buffer_store_dword v21, v20, s[16:19], 0 offen sc1
    s_mov_b64 exec, -1
L_V_nold:
    buffer_load_dwordx4 v[156:159], v16, s[16:19], 0 offen sc1
    s_waitcnt vmcnt(0) lgkmcnt(0)
    s_barrier
    s_setprio 3
L_V_step:
    s_mov_b32 s32, s31
poll_35:
    buffer_load_dwordx4 v[20:23], v2, s[16:19], s45 offen sc1
    buffer_load_dwordx4 v[24:27], v3, s[16:19], s45 offen sc1
    s_waitcnt vmcnt(0)
    v_max3_u32 v19, v20, v21, v22
    v_max3_u32 v19, v19, v23, v24
    v_max3_u32 v19, v19, v25, v26
    v_max_u32 v19, v19, v27
    v_cmp_eq_u32 vcc, -1, v19
    s_cbranch_vccz polled_36
    s_sub_u32 s32, s32, 1
    s_cmp_lg_u32 s32, 0
    s_cbranch_scc1 poll_35
    s_mov_b32 s31, 1
polled_36:
    s_cmp_ge_u32 s56, 64
    s_cbranch_scc1 L_V_vxok
    s_mov_b32 s32, s31
L_V_vxchk:
    v_min3_u32 v19, v156, v157, v158
    v_min_u32 v19, v19, v159
    s_nop 0
    v_readlane_b32 s41, v19, 0
    v_readlane_b32 s42, v19, 1
    v_readlane_b32 s43, v19, 2
    v_readlane_b32 s44, v19, 3
    buffer_load_dwordx4 v[156:159], v16, s[16:19], 0 offen sc1
    s_min_u32 s41, s41, s42
    s_min_u32 s43, s43, s44
    s_min_u32 s56, s41, s43
    s_lshl_b32 s56, s56, 2
    s_cmp_lt_u32 s33, s56
    s_cbranch_scc1 L_V_vxok
    s_waitcnt vmcnt(0)
    s_sub_u32 s32, s32, 1
    s_cmp_lg_u32 s32, 0
    s_cbranch_scc1 L_V_vxchk
    s_mov_b32 s31, 1
L_V_vxok:
    v_smfmac_f32_16x16x64_bf16 v[48:51], v[20:23], a[0:7], v1
    ds_write_b64 v2, v[20:21] offset:0
    v_smfmac_f32_16x16x64_bf16 v[52:55], v[20:23], a[8:15], v1
    ds_write_b64 v2, v[22:23] offset:8
    v_smfmac_f32_16x16x64_bf16 v[56:59], v[20:23], a[16:23], v1
    ds_write_b64 v3, v[24:25] offset:0
    v_smfmac_f32_16x16x64_bf16 v[60:63], v[20:23], a[24:31], v1
    ds_write_b64 v3, v[26:27] offset:8
    v_smfmac_f32_16x16x64_bf16 v[64:67], v[20:23], a[32:39], v1
    s_add_u32 s41, s47, 0
    buffer_load_dwordx4 v[80:83], v9, s[16:19], s41 offen sc1
    v_smfmac_f32_16x16x64_bf16 v[68:71], v[20:23], a[40:47], v1
    buffer_load_dwordx4 v[96:99], v9, s[16:19], s41 offen offset:1024 sc1
    v_smfmac_f32_16x16x64_bf16 v[72:75], v[20:23], a[48:55], v1
    s_add_u32 s41, s47, 28672
    buffer_load_dwordx4 v[84:87], v9, s[16:19], s41 offen sc1
    v_smfmac_f32_16x16x64_bf16 v[76:79], v[20:23], a[56:63], v1
    buffer_load_dwordx4 v[100:103], v9, s[16:19], s41 offen offset:1024 sc1
    v_smfmac_f32_16x16x64_bf16 v[48:51], v[24:27], a[64:71], v1
    s_add_u32 s41, s47, 57344
    buffer_load_dwordx4 v[88:91], v9, s[16:19], s41 offen sc1
    v_smfmac_f32_16x16x64_bf16 v[52:55], v[24:27], a[72:79], v1
    buffer_load_dwordx4 v[104:107], v9, s[16:19], s41 offen offset:1024 sc1
    s_waitcnt lgkmcnt(0)
    s_barrier
    ds_read_b128 v[28:31], v4
    v_smfmac_f32_16x16x64_bf16 v[56:59], v[24:27], a[80:87], v1
    ds_read_b128 v[32:35], v5
    v_smfmac_f32_16x16x64_bf16 v[60:63], v[24:27], a[88:95], v1
    ds_read_b128 v[36:39], v6
    v_smfmac_f32_16x16x64_bf16 v[64:67], v[24:27], a[96:103], v1
    ds_read_b128 v[40:43], v7
    v_smfmac_f32_16x16x64_bf16 v[68:71], v[24:27], a[104:111], v1
    ds_read_b128 v[44:47], v8
    v_smfmac_f32_16x16x64_bf16 v[72:75], v[24:27], a[112:119], v1
    s_add_u32 s41, s47, 86016
    buffer_load_dwordx4 v[92:95], v9, s[16:19], s41 offen sc1
    v_smfmac_f32_16x16x64_bf16 v[76:79], v[24:27], a[120:127], v1
    buffer_load_dwordx4 v[108:111], v9, s[16:19], s41 offen offset:1024 sc1
    s_add_u32 s47, s47, 458752
    s_waitcnt lgkmcnt(4)
    v_smfmac_f32_16x16x64_bf16 v[48:51], v[28:31], a[128:135], v1
    ds_read_b128 v[140:143], v15 offset:0
    s_waitcnt lgkmcnt(4)
    v_smfmac_f32_16x16x64_bf16 v[48:51], v[32:35], a[136:143], v1
    ds_read_b128 v[144:147], v15 offset:1024
    s_waitcnt lgkmcnt(4)
    v_smfmac_f32_16x16x64_bf16 v[48:51], v[36:39], a[144:151], v1
    ds_read_b128 v[148:151], v15 offset:2048
    s_waitcnt lgkmcnt(4)
    v_smfmac_f32_16x16x64_bf16 v[48:51], v[40:43], a[152:159], v1
    ds_read_b128 v[152:155], v15 offset:3072
    s_waitcnt lgkmcnt(4)
    v_smfmac_f32_16x16x64_bf16 v[48:51], v[44:47], a[160:167], v1
    s_waitcnt lgkmcnt(2)
    v_smfmac_f32_16x16x64_bf16 v[52:55], v[28:31], v[140:147], v1
    ds_read_b128 v[140:143], v15 offset:4096
    v_smfmac_f32_16x16x64_bf16 v[52:55], v[32:35], a[168:175], v1
    ds_read_b128 v[144:147], v15 offset:5120
    v_smfmac_f32_16x16x64_bf16 v[52:55], v[36:39], a[176:183], v1
    s_waitcnt lgkmcnt(2)
    v_smfmac_f32_16x16x64_bf16 v[52:55], v[40:43], v[148:155], v1
    ds_read_b128 v[148:151], v15 offset:6144
    v_smfmac_f32_16x16x64_bf16 v[52:55], v[44:47], a[184:191], v1
    ds_read_b128 v[152:155], v15 offset:7168
    v_cvt_pk_bf16_f32 v112, v48, v49
    v_smfmac_f32_16x16x64_bf16 v[56:59], v[28:31], a[192:199], v1
    v_cvt_pk_bf16_f32 v113, v50, v51
    s_waitcnt lgkmcnt(2)
    v_smfmac_f32_16x16x64_bf16 v[56:59], v[32:35], v[140:147], v1
    ds_read_b128 v[140:143], v15 offset:8192
    v_smfmac_f32_16x16x64_bf16 v[56:59], v[36:39], a[200:207], v1
    ds_read_b128 v[144:147], v15 offset:9216
    v_smfmac_f32_16x16x64_bf16 v[56:59], v[40:43], a[208:215], v1
    s_waitcnt lgkmcnt(2)
    v_smfmac_f32_16x16x64_bf16 v[56:59], v[44:47], v[148:155], v1
    ds_read_b128 v[148:151], v15 offset:10240
    v_cvt_pk_bf16_f32 v120, v52, v53
    v_smfmac_f32_16x16x64_bf16 v[60:63], v[28:31], a[216:223], v1
    ds_read_b128 v[152:155], v15 offset:11264
    v_cvt_pk_bf16_f32 v121, v54, v55
    v_smfmac_f32_16x16x64_bf16 v[60:63], v[32:35], a[224:231], v1
    s_waitcnt lgkmcnt(2)
    v_smfmac_f32_16x16x64_bf16 v[60:63], v[36:39], v[140:147], v1
    ds_read_b128 v[140:143], v15 offset:12288
    v_smfmac_f32_16x16x64_bf16 v[60:63], v[40:43], a[232:239], v1
    ds_read_b128 v[144:147], v15 offset:13312
    v_smfmac_f32_16x16x64_bf16 v[60:63], v[44:47], a[240:247], v1
    v_cvt_pk_bf16_f32 v114, v56, v57
    s_waitcnt lgkmcnt(2)
    v_smfmac_f32_16x16x64_bf16 v[64:67], v[28:31], v[148:155], v1
    ds_read_b128 v[148:151], v15 offset:14336
    v_cvt_pk_bf16_f32 v115, v58, v59
    v_smfmac_f32_16x16x64_bf16 v[64:67], v[32:35], a[248:255], v1
    ds_read_b128 v[152:155], v15 offset:15360
    v_mov_b32 v48, 0
    v_smfmac_f32_16x16x64_bf16 v[64:67], v[36:39], v[160:167], v1
    s_waitcnt lgkmcnt(2)
    v_smfmac_f32_16x16x64_bf16 v[64:67], v[40:43], v[140:147], v1
    ds_read_b128 v[140:143], v15 offset:16384
    v_mov_b32 v49, 0
    v_smfmac_f32_16x16x64_bf16 v[64:67], v[44:47], v[168:175], v1
    ds_read_b128 v[144:147], v15 offset:17408
    v_cvt_pk_bf16_f32 v122, v60, v61
    v_smfmac_f32_16x16x64_bf16 v[68:71], v[28:31], v[176:183], v1
    v_cvt_pk_bf16_f32 v123, v62, v63
    v_mov_b32 v50, 0
    s_waitcnt lgkmcnt(2)
    v_smfmac_f32_16x16x64_bf16 v[68:71], v[32:35], v[148:155], v1
    ds_read_b128 v[148:151], v15 offset:18432
    v_smfmac_f32_16x16x64_bf16 v[68:71], v[36:39], v[184:191], v1
    ds_read_b128 v[152:155], v15 offset:19456
    v_mov_b32 v51, 0
    v_smfmac_f32_16x16x64_bf16 v[68:71], v[40:43], v[192:199], v1
    s_waitcnt lgkmcnt(2)
    v_smfmac_f32_16x16x64_bf16 v[68:71], v[44:47], v[140:147], v1
    ds_read_b128 v[140:143], v15 offset:20480
    v_cvt_pk_bf16_f32 v116, v64, v65
    v_mov_b32 v52, 0
    v_smfmac_f32_16x16x64_bf16 v[72:75], v[28:31], v[200:207], v1
    ds_read_b128 v[144:147], v15 offset:21504
    v_cvt_pk_bf16_f32 v117, v66, v67
    v_smfmac_f32_16x16x64_bf16 v[72:75], v[32:35], v[208:215], v1
    v_mov_b32 v53, 0
    s_waitcnt lgkmcnt(2)
    v_smfmac_f32_16x16x64_bf16 v[72:75], v[36:39], v[148:155], v1
    ds_read_b128 v[148:151], v15 offset:22528
    v_smfmac_f32_16x16x64_bf16 v[72:75], v[40:43], v[216:223], v1
    ds_read_b128 v[152:155], v15 offset:23552
    v_mov_b32 v54, 0
    v_smfmac_f32_16x16x64_bf16 v[72:75], v[44:47], v[224:231], v1
    v_cvt_pk_bf16_f32 v124, v68, v69
    s_waitcnt lgkmcnt(2)
    v_smfmac_f32_16x16x64_bf16 v[76:79], v[28:31], v[140:147], v1
    v_cvt_pk_bf16_f32 v125, v70, v71
    v_mov_b32 v55, 0
    v_smfmac_f32_16x16x64_bf16 v[76:79], v[32:35], v[232:239], v1
    v_smfmac_f32_16x16x64_bf16 v[76:79], v[36:39], v[240:247], v1
    s_waitcnt lgkmcnt(0)
    v_smfmac_f32_16x16x64_bf16 v[76:79], v[40:43], v[148:155], v1
    v_smfmac_f32_16x16x64_bf16 v[76:79], v[44:47], v[248:255], v1
    v_cvt_pk_bf16_f32 v118, v72, v73
    v_cvt_pk_bf16_f32 v119, v74, v75
    s_nop 5
    v_cvt_pk_bf16_f32 v126, v76, v77
    v_cvt_pk_bf16_f32 v127, v78, v79
    s_mov_b32 s32, s31
L_V_pollA:
    buffer_load_dwordx4 v[128:131], v10, s[16:19], s46 offen offset:0 sc1
    buffer_load_dwordx4 v[132:135], v10, s[16:19], s46 offen offset:1024 sc1
    buffer_load_dwordx4 v[136:139], v10, s[16:19], s46 offen offset:2048 sc1
    s_waitcnt vmcnt(2)
    v_max3_u32 v19, v128, v129, v130
    v_max_u32 v19, v19, v131
    v_cmp_eq_u32 vcc, -1, v19
    s_cbranch_vccz polled_V
    s_sub_u32 s32, s32, 1
    s_cmp_lg_u32 s32, 0
    s_cbranch_scc1 L_V_pollA
    s_mov_b32 s31, 1
polled_V:
    v_smfmac_f32_16x16x64_bf16 v[48:51], v[128:131], v[80:87], v1
    v_smfmac_f32_16x16x64_bf16 v[52:55], v[128:131], v[96:103], v1
    s_waitcnt vmcnt(1)
    v_max3_u32 v19, v132, v133, v134
    v_max_u32 v19, v19, v135
    v_cmp_eq_u32 vcc, -1, v19
    s_cbranch_vccz L_V_c0
    s_mov_b32 s32, s31
L_V_pollB:
    buffer_load_dwordx4 v[132:135], v10, s[16:19], s46 offen offset:1024 sc1
    buffer_load_dwordx4 v[136:139], v10, s[16:19], s46 offen offset:2048 sc1
    s_waitcnt vmcnt(1)
    v_max3_u32 v19, v132, v133, v134
    v_max_u32 v19, v19, v135
    v_cmp_eq_u32 vcc, -1, v19
    s_cbranch_vccz L_V_cb
    s_sub_u32 s32, s32, 1
    s_cmp_lg_u32 s32, 0
    s_cbranch_scc1 L_V_pollB
    s_mov_b32 s31, 1
L_V_cb:
    v_smfmac_f32_16x16x64_bf16 v[48:51], v[132:135], v[88:95], v1
    v_smfmac_f32_16x16x64_bf16 v[52:55], v[132:135], v[104:111], v1
    s_waitcnt vmcnt(0)
    s_branch L_V_cchk
L_V_c0:
    v_smfmac_f32_16x16x64_bf16 v[48:51], v[132:135], v[88:95], v1
    v_smfmac_f32_16x16x64_bf16 v[52:55], v[132:135], v[104:111], v1
    s_waitcnt vmcnt(0)
L_V_cchk:
    v_max3_u32 v19, v136, v137, v138
    v_max_u32 v19, v19, v139
    v_cmp_eq_u32 vcc, -1, v19
    s_cbranch_vccz L_V_pok
    s_mov_b32 s32, s31
L_V_pollC:
    buffer_load_dwordx4 v[136:139], v10, s[16:19], s46 offen offset:2048 sc1
    s_waitcnt vmcnt(0)
    v_max3_u32 v19, v136, v137, v138
    v_max_u32 v19, v19, v139
    v_cmp_eq_u32 vcc, -1, v19
    s_cbranch_vccz L_V_pok
    s_sub_u32 s32, s32, 1
    s_cmp_lg_u32 s32, 0
    s_cbranch_scc1 L_V_pollC
    s_mov_b32 s31, 1
L_V_pok:
    v_smfmac_f32_16x16x64_bf16 v[48:51], v[136:139], v[112:119], v1
    v_smfmac_f32_16x16x64_bf16 v[52:55], v[136:139], v[120:127], v1
    s_add_u32 s45, s45, 7168
    s_nop 4
    v_add_f32 v56, v48, v49
    v_add_f32 v58, v50, v51
    v_add_f32 v57, v52, v53
    v_add_f32 v59, v54, v55
    ds_write_b128 v11, v[56:59]
    s_cmp_ge_u32 s28, 2
    s_waitcnt lgkmcnt(0)
    s_barrier
    s_cbranch_scc1 L_V_idle
    ds_read_b64 v[60:61], v12 offset:0
    ds_read_b64 v[62:63], v12 offset:1024
    ds_read_b64 v[64:65], v12 offset:2048
    ds_read_b64 v[66:67], v12 offset:3072
    s_waitcnt lgkmcnt(2)
    v_pk_add_f32 v[60:61], v[60:61], v[62:63]
    s_waitcnt lgkmcnt(0)
    v_pk_add_f32 v[64:65], v[64:65], v[66:67]
    v_pk_add_f32 v[60:61], v[60:61], v[64:65]
    v_cvt_pk_bf16_f32 v62, v60, v61
    buffer_store_dword v62, v13, s[16:19], s45 offen
    s_cmp_lg_u32 s33, 99
    s_cbranch_scc1 L_V_nodir
    s_add_u32 s41, s45, 1245184
    buffer_store_dword v62, v13, s[16:19], s41 offen sc1
L_V_nodir:
    s_cmp_eq_u32 s30, 0
    s_cbranch_scc1 L_V_nofb
    buffer_store_dword v62, v13, s[16:19], s45 offen sc1
L_V_nofb:
    s_branch L_V_join
L_V_idle:
    s_sleep 4
L_V_join:
    v_mov_b32 v48, 0
    v_mov_b32 v49, 0
    v_mov_b32 v50, 0
    v_mov_b32 v51, 0
    v_mov_b32 v52, 0
    v_mov_b32 v53, 0
    v_mov_b32 v54, 0
    v_mov_b32 v55, 0
    v_mov_b32 v56, 0
    v_mov_b32 v57, 0
    v_mov_b32 v58, 0
    v_mov_b32 v59, 0
    v_mov_b32 v60, 0
    v_mov_b32 v61, 0
    v_mov_b32 v63, 0
    v_mov_b32 v64, 0
    v_mov_b32 v65, 0
    v_mov_b32 v66, 0
    v_mov_b32 v67, 0
    v_mov_b32 v68, 0
    v_mov_b32 v69, 0
    v_mov_b32 v70, 0
    v_mov_b32 v71, 0
    v_mov_b32 v72, 0
    v_mov_b32 v73, 0
    v_mov_b32 v74, 0
    v_mov_b32 v75, 0
    v_mov_b32 v76, 0
    v_mov_b32 v77, 0
    v_mov_b32 v78, 0
    v_mov_b32 v79, 0
    v_mov_b32 v62, 0
    s_add_u32 s57, s57, 0
    s_add_u32 s46, s46, 12288
    s_add_u32 s33, s33, 1
    s_cmp_lt_u32 s33, 63
    s_cbranch_scc1 L_V_step
    s_cmp_eq_u32 s33, 101
    s_cbranch_scc1 L_V_dryret
    s_waitcnt vmcnt(0)
    s_endpgm
L_role_W:
    v_and_b32 v40, 63, v0
    s_cmp_lg_u32 s28, 0
    s_cbranch_scc1 fld_38
    v_and_b32 v20, 31, v40
    v_lshlrev_b32 v20, 6, v20
    v_add_u32 v20, 14356, v20
    s_mov_b32 s32, 200000
    s_mov_b32 s41, 95125504
fl_37:
    buffer_load_dword v21, v20, s[16:19], s41 offen sc1
    s_waitcnt vmcnt(0)
    v_cmp_eq_u32 vcc, s59, v21
    s_nop 0
    s_cmp_eq_u64 vcc, -1
    s_cbranch_scc1 fld_38
    s_sleep 4
    s_sub_u32 s32, s32, 1
    s_cmp_lg_u32 s32, 0
    s_cbranch_scc1 fl_37
fld_38:
    s_barrier
    v_and_b32 v20, 15, v40
    v_cmp_eq_u32 vcc, 8, v20
    v_lshlrev_b32 v20, 5, v20
    v_min_u32 v20, 252, v20
    v_cndmask_b32 v20, v20, 28, vcc
    s_mov_b32 s32, 200000
cm_39:
    buffer_load_dword v21, v20, s[24:27], 0 offen sc1
    s_waitcnt vmcnt(0)
    v_readlane_b32 s41, v21, 0
    s_mov_b32 s30, 0
    s_cmp_ge_u32 s41, 32
    s_cbranch_scc1 cmd_40
    s_mov_b32 s30, 1
    v_readlane_b32 s43, v21, 1
    s_nop 0
    s_add_u32 s41, s41, s43
    v_readlane_b32 s43, v21, 2
    s_nop 0
    s_add_u32 s41, s41, s43
    v_readlane_b32 s43, v21, 3
    s_nop 0
    s_add_u32 s41, s41, s43
    v_readlane_b32 s43, v21, 4
    s_nop 0
    s_add_u32 s41, s41, s43
    v_readlane_b32 s43, v21, 5
    s_nop 0
    s_add_u32 s41, s41, s43
    v_readlane_b32 s43, v21, 6
    s_nop 0
    s_add_u32 s41, s41, s43
    v_readlane_b32 s43, v21, 7
    s_nop 0
    s_add_u32 s41, s41, s43
    v_readlane_b32 s43, v21, 8
    s_nop 0
    s_add_u32 s41, s41, s43
    s_cmp_ge_u32 s41, 256
    s_cbranch_scc1 cmd_40
    s_sleep 2
    s_sub_u32 s32, s32, 1
    s_cmp_lg_u32 s32, 0
    s_cbranch_scc1 cm_39
cmd_40:
    s_cmp_eq_u32 s30, 0
    s_cbranch_scc1 nofix_41
    buffer_wbl2 sc1
    s_waitcnt vmcnt(0)
    s_mov_b32 s89, 244
    s_waitcnt vmcnt(0)
    s_barrier
    s_cmp_lg_u32 s28, 0
    s_cbranch_scc1 arr_42
    v_mov_b32 v20, s89
    v_mov_b32 v21, 1
    s_mov_b64 exec, 1
    buffer_atomic_add v21, v20, s[24:27], 0 offen sc1
    s_mov_b64 exec, -1
arr_42:
    s_cmp_lg_u32 s28, 0
    s_cbranch_scc1 cwd_44
    v_mov_b32 v20, 244
    v_mov_b32 v21, 32
    s_mov_b32 s32, 200000
    s_mov_b64 exec, 7
cw_43:
    buffer_load_dword v22, v20, s[24:27], 0 offen sc1
    s_waitcnt vmcnt(0)
    v_cmp_le_u32 vcc, v21, v22
    s_nop 0
    s_cmp_eq_u64 vcc, 7
    s_cbranch_scc1 cwd_44
    s_sleep 16
    s_sub_u32 s32, s32, 1
    s_cmp_lg_u32 s32, 0
    s_cbranch_scc1 cw_43
cwd_44:
    s_mov_b64 exec, -1
    s_barrier
nofix_41:
    v_and_b32 v40, 63, v0
    s_mov_b32 s31, 200000
    s_mov_b32 s45, 71572480
    s_cmp_eq_u32 s29, 31
    s_cbranch_scc1 L_W_warm
    s_lshl_b32 s41, s28, 11
    s_min_u32 s41, s41, 5120
    v_lshl_add_u32 v6, v40, 4, s41
    s_mov_b32 s33, 1
    v_mov_b32 v8, 73285568
L_R_step:
    s_mov_b32 s32, s31
L_R_poll:
    buffer_load_dwordx4 v[20:23], v6, s[16:19], s45 offen sc1
    buffer_load_dwordx4 v[24:27], v6, s[16:19], s45 offen offset:1024 sc1
    s_waitcnt vmcnt(0)
    v_max3_u32 v5, v20, v21, v22
    v_max3_u32 v5, v5, v23, v24
    v_max3_u32 v5, v5, v25, v26
    v_max_u32 v5, v5, v27
    v_cmp_eq_u32 vcc, -1, v5
    s_cbranch_vccz L_R_go
    s_sleep 2
    s_sub_u32 s32, s32, 1
    s_cmp_lg_u32 s32, 0
    s_cbranch_scc1 L_R_poll
    s_mov_b32 s31, 1
L_R_go:
    s_add_u32 s41, s45, 1245184
    buffer_store_dwordx4 v[20:23], v6, s[16:19], s41 offen sc1
    buffer_store_dwordx4 v[24:27], v6, s[16:19], s41 offen offset:1024 sc1
    s_add_u32 s45, s45, 7168
    v_mov_b32 v7, s33
    s_waitcnt vmcnt(0)
    s_barrier
    s_cmp_lg_u32 s28, 0
    s_cbranch_scc1 L_R_nf
    s_mov_b64 exec, 1
    buffer_store_dword v7, v8, s[16:19], 0 offen sc1
    s_mov_b64 exec, -1
L_R_nf:
    s_sleep 8
    s_add_u32 s33, s33, 1
    s_cmp_lt_u32 s33, 64
    s_cbranch_scc1 L_R_step
    s_waitcnt vmcnt(0)
    s_endpgm
L_W_warm:
    s_lshl_b32 s42, s28, 12
    v_lshlrev_b32 v20, 6, v40
    v_add3_u32 v20, v20, 16, s42
    s_mov_b32 s32, 200000
    s_mov_b32 s41, 95125504
fl_45:
    buffer_load_dword v21, v20, s[16:19], s41 offen sc1
    s_waitcnt vmcnt(0)
    v_cmp_eq_u32 vcc, s59, v21
    s_nop 0
    s_cmp_eq_u64 vcc, -1
    s_cbranch_scc1 fld_46
    s_sleep 2
    s_sub_u32 s32, s32, 1
    s_cmp_lg_u32 s32, 0
    s_cbranch_scc1 fl_45
fld_46:
    s_barrier
    v_mov_b32 v20, 95142016
    v_mov_b32 v21, s59
    s_mov_b64 exec, 1
    buffer_store_dword v21, v20, s[16:19], 0 offen sc1
    s_mov_b64 exec, -1
    v_lshlrev_b32 v2, 7, v40
    v_mov_b32 v9, 0
    s_lshl_b32 s80, s28, 13
    s_add_u32 s80, s80, 73285632
    s_sub_u32 s41, s28, 1
    s_mul_i32 s81, s41, 6144
    s_add_u32 s81, s81, 72024064
    s_mov_b32 s82, 12288
    s_cmp_eq_u32 s28, 0
    s_cselect_b32 s81, 71565312, s81
    s_cselect_b32 s82, 7168, s82
    s_cmp_eq_u32 s28, 3
    s_cselect_b32 s81, 2147483632, s81
    s_cselect_b32 s82, 0, s82
    s_mov_b32 s33, 0
L_W_step:
    s_cmp_lt_u32 s33, 4
    s_cbranch_scc1 L_W_paced
    s_mov_b32 s32, s31
L_W_pace:
    buffer_load_dword v5, v9, s[16:19], s45 offen sc1
    s_waitcnt vmcnt(0)
    v_cmp_eq_u32 vcc, -1, v5
    s_cbranch_vccz L_W_paced2
    s_sleep 4
    s_sub_u32 s32, s32, 1
    s_cmp_lg_u32 s32, 0
    s_cbranch_scc1 L_W_pace
    s_mov_b32 s31, 1
L_W_paced2:
    s_add_u32 s45, s45, 7168
L_W_paced:
    buffer_load_dword v8, v2, s[16:19], s80 offen sc1
    buffer_load_dword v10, v2, s[16:19], s81 offen sc1
    s_add_u32 s80, s80, 32768
    s_add_u32 s81, s81, s82
    s_add_u32 s33, s33, 1
    s_cmp_lt_u32 s33, 64
    s_cbranch_scc1 L_W_step
    s_waitcnt vmcnt(0)
    s_endpgm
L_overflow:
    v_and_b32 v4, 15, v0
    v_cmp_eq_u32 vcc, 8, v4
    v_lshlrev_b32 v4, 5, v4
    v_min_u32 v4, 252, v4
    v_cndmask_b32 v4, v4, 28, vcc
    s_mov_b32 s32, 200000
wa_47:
    buffer_load_dword v5, v4, s[24:27], 0 offen sc1
    s_waitcnt vmcnt(0)
    s_mov_b32 s41, 0
    v_readlane_b32 s64, v5, 0
    v_readlane_b32 s65, v5, 1
    v_readlane_b32 s66, v5, 2
    v_readlane_b32 s67, v5, 3
    v_readlane_b32 s68, v5, 4
    v_readlane_b32 s69, v5, 5
    v_readlane_b32 s70, v5, 6
    v_readlane_b32 s71, v5, 7
    v_readlane_b32 s72, v5, 8
    s_add_u32 s41, s41, s64
    s_add_u32 s41, s41, s65
    s_add_u32 s41, s41, s66
    s_add_u32 s41, s41, s67
    s_add_u32 s41, s41, s68
    s_add_u32 s41, s41, s69
    s_add_u32 s41, s41, s70
    s_add_u32 s41, s41, s71
    s_add_u32 s41, s41, s72
    s_cmp_ge_u32 s41, 256
    s_cbranch_scc1 wad_48
    s_sleep 2
    s_sub_u32 s32, s32, 1
    s_cmp_lg_u32 s32, 0
    s_cbranch_scc1 wa_47
wad_48:
    s_sub_u32 s42, s43, 32
    s_cmp_lt_u32 s44, 8
    s_cselect_b32 s42, s42, s43
    s_sub_u32 s41, s64, 32
    s_max_i32 s41, s41, 0
    s_cmp_lt_u32 0, s44
    s_cselect_b32 s41, s41, 0
    s_add_u32 s42, s42, s41
    s_sub_u32 s41, s65, 32
    s_max_i32 s41, s41, 0
    s_cmp_lt_u32 1, s44
    s_cselect_b32 s41, s41, 0
    s_add_u32 s42, s42, s41
    s_sub_u32 s41, s66, 32
    s_max_i32 s41, s41, 0
    s_cmp_lt_u32 2, s44
    s_cselect_b32 s41, s41, 0
    s_add_u32 s42, s42, s41
    s_sub_u32 s41, s67, 32
    s_max_i32 s41, s41, 0
    s_cmp_lt_u32 3, s44
    s_cselect_b32 s41, s41, 0
    s_add_u32 s42, s42, s41
    s_sub_u32 s41, s68, 32
    s_max_i32 s41, s41, 0
    s_cmp_lt_u32 4, s44
    s_cselect_b32 s41, s41, 0
    s_add_u32 s42, s42, s41
    s_sub_u32 s41, s69, 32
    s_max_i32 s41, s41, 0
    s_cmp_lt_u32 5, s44
    s_cselect_b32 s41, s41, 0
    s_add_u32 s42, s42, s41
    s_sub_u32 s41, s70, 32
    s_max_i32 s41, s41, 0
    s_cmp_lt_u32 6, s44
    s_cselect_b32 s41, s41, 0
    s_add_u32 s42, s42, s41
    s_sub_u32 s41, s71, 32
    s_max_i32 s41, s41, 0
    s_cmp_lt_u32 7, s44
    s_cselect_b32 s41, s41, 0
    s_add_u32 s42, s42, s41
    s_mov_b32 s29, 0xfff
    s_min_u32 s41, s64, 32
    s_sub_u32 s43, 32, s41
    s_add_u32 s41, s41, s42
    s_add_u32 s41, s41, 0
    s_cmp_lt_u32 s42, s43
    s_cselect_b32 s29, s41, s29
    s_sub_u32 s42, s42, s43
    s_min_u32 s41, s65, 32
    s_sub_u32 s43, 32, s41
    s_add_u32 s41, s41, s42
    s_add_u32 s41, s41, 32
    s_cmp_lt_u32 s42, s43
    s_cselect_b32 s29, s41, s29
    s_sub_u32 s42, s42, s43
    s_min_u32 s41, s66, 32
    s_sub_u32 s43, 32, s41
    s_add_u32 s41, s41, s42
    s_add_u32 s41, s41, 64
    s_cmp_lt_u32 s42, s43
    s_cselect_b32 s29, s41, s29
    s_sub_u32 s42, s42, s43
    s_min_u32 s41, s67, 32
    s_sub_u32 s43, 32, s41
    s_add_u32 s41, s41, s42
    s_add_u32 s41, s41, 96
    s_cmp_lt_u32 s42, s43
    s_cselect_b32 s29, s41, s29
    s_sub_u32 s42, s42, s43
    s_min_u32 s41, s68, 32
    s_sub_u32 s43, 32, s41
    s_add_u32 s41, s41, s42
    s_add_u32 s41, s41, 128
    s_cmp_lt_u32 s42, s43
    s_cselect_b32 s29, s41, s29
    s_sub_u32 s42, s42, s43
    s_min_u32 s41, s69, 32
    s_sub_u32 s43, 32, s41
    s_add_u32 s41, s41, s42
    s_add_u32 s41, s41, 160
    s_cmp_lt_u32 s42, s43
    s_cselect_b32 s29, s41, s29
    s_sub_u32 s42, s42, s43
    s_min_u32 s41, s70, 32
    s_sub_u32 s43, 32, s41
    s_add_u32 s41, s41, s42
    s_add_u32 s41, s41, 192
    s_cmp_lt_u32 s42, s43
    s_cselect_b32 s29, s41, s29
    s_sub_u32 s42, s42, s43
    s_min_u32 s41, s71, 32
    s_sub_u32 s43, 32, s41
    s_add_u32 s41, s41, s42
    s_add_u32 s41, s41, 224
    s_cmp_lt_u32 s42, s43
    s_cselect_b32 s29, s41, s29
    s_sub_u32 s42, s42, s43
    s_branch L_elect_done
L_code_end:
.set CODE_BYTES, L_code_end-gated_mix__memory_aug_recurrent_mem_tr__moe_arch_mod__prompt_kernel
.section .rodata,"a"
.p2align 6
.amdhsa_kernel gated_mix__memory_aug_recurrent_mem_tr__moe_arch_mod__prompt_kernel
  .amdhsa_next_free_vgpr 512
  .amdhsa_next_free_sgpr 102
  .amdhsa_accum_offset 256
  .amdhsa_group_segment_fixed_size 0
  .amdhsa_kernarg_size 128
  .amdhsa_user_sgpr_count 2
  .amdhsa_user_sgpr_kernarg_segment_ptr 1
  .amdhsa_system_sgpr_workgroup_id_x 1
.end_amdhsa_kernel
```
